```python
import torch

def _softmax(x, axis=-1):
    return torch.softmax(x, dim=axis)
def _gelu(x):
    return torch.nn.functional.gelu(x, approximate="tanh")
def _silu(x):
    return torch.nn.functional.silu(x)
def _sigmoid(x):
    return torch.sigmoid(x)
def _layernorm(x, axis=-1, eps=1e-5):
    m = x.mean(dim=axis, keepdim=True)
    v = x.var(dim=axis, keepdim=True, unbiased=False)
    return (x - m) / torch.sqrt(v + eps)
def _scatter_add(tgt, idx, src, axis=0):
    return tgt.clone().index_add_(axis, idx, src)
def _segment_sum(src, seg, n):
    out = torch.zeros((n,) + src.shape[1:], dtype=src.dtype)
    return out.index_add_(0, seg, src)
def _pad(x, pw):
    flat = tuple(v for pair in reversed(pw) for v in pair)
    return torch.nn.functional.pad(x, flat)

kernel_name = 'standalone__gqa_softmax__near_ridge'

def setup_inputs():

    _w = (lambda a: (lambda t: t.to(torch.bfloat16) if t.is_floating_point() else t)(torch.as_tensor(a)))
    B, Hq, Hkv, Sq, Sk, D = 8, 32, 32, 496, 512, 128
    return {
        "q": _w((lambda *s: torch.randn(*s, dtype=torch.bfloat16) * 0.8)(B, Hq, Sq, D)),
        "k": _w((lambda *s: torch.randn(*s, dtype=torch.bfloat16) * 0.8)(B, Hkv, Sk, D)),
        "v": _w((lambda *s: torch.randn(*s, dtype=torch.bfloat16) * 0.05)(B, Hkv, Sk, D)),
    }

def reference(q, k, v):
    B, Hq, Sq, D = q.shape
    Hkv = k.shape[1]
    rep = Hq // Hkv
    k = (lambda x, n, axis: torch.repeat_interleave(x, n, dim=axis))(k, rep, axis=1)
    v = (lambda x, n, axis: torch.repeat_interleave(x, n, dim=axis))(v, rep, axis=1)
    scale = D ** -0.5
    scores = torch.einsum("bhqd,bhkd->bhqk", q, k) * scale
    p = _softmax(scores, axis=-1)
    return torch.einsum("bhqk,bhkd->bhqd", p, v)
```

```asm
; @launch grid=(256,1,1) block=(256,1,1) lds=138240
.amdgcn_target "amdgcn-amd-amdhsa--gfx950"
.text
.globl standalone__gqa_softmax__near_ridge_kernel
.p2align 8
.type standalone__gqa_softmax__near_ridge_kernel,@function
standalone__gqa_softmax__near_ridge_kernel:
s_cmp_ge_u32 s2, 256
s_cbranch_scc1 L_end
s_load_dwordx4 s[4:7], s[0:1], 0
s_load_dwordx4 s[8:11], s[0:1], 16
s_getpc_b64 s[52:53]
L_pc:
v_lshlrev_b32 v250, 6, v0
v_mov_b32 v253, s53
v_add_co_u32 v252, vcc, s52, v250
v_lshrrev_b32 v1, 6, v0
s_nop 0
v_addc_co_u32 v253, vcc, 0, v253, vcc
global_load_dword v254, v[252:253], off
v_and_b32 v2, 63, v0
v_readfirstlane_b32 s3, v1
v_lshrrev_b32 v5, 4, v2
v_and_b32 v6, 15, v2
v_and_b32 v7, 3, v6
v_lshrrev_b32 v3, 2, v6
v_xor_b32 v8, v7, v5
v_and_b32 v9, 12, v6
v_or_b32 v8, v8, v9
v_lshlrev_b32 v9, 8, v5
v_lshl_add_u32 v9, v8, 4, v9
s_lshl_b32 s41, s3, 10
v_add_u32 v226, s41, v9
v_add_u32 v227, 4096, v226
s_lshl_b32 s41, s3, 15
v_add_u32 v230, s41, v9
s_lshl_b32 s41, s3, 8
v_lshlrev_b32 v12, 11, v5
v_lshl_add_u32 v12, v6, 4, v12
v_add_u32 v228, s41, v12
v_add_u32 v229, 1024, v228
s_mul_i32 s46, s3, 1088
s_mul_i32 s41, s3, 1056
s_sub_u32 s44, s41, s46
s_add_u32 s44, s44, 8704
s_add_u32 s45, s44, 4224
s_mul_i32 s47, s3, 17408
s_add_u32 s47, s47, 68608
s_mov_b32 s48, s47
s_mov_b32 s34, s46
s_mov_b32 s35, 0
s_mul_i32 s14, s2, 126976
s_lshl_b32 s15, s2, 17
s_mov_b32 s22, 131072
s_mov_b32 s23, 0x20000
s_mov_b32 s26, 131072
s_mov_b32 s27, 0x20000
s_mov_b32 s18, 126976
s_mov_b32 s19, 0x20000
s_mov_b32 s30, 126976
s_mov_b32 s31, 0x20000
s_waitcnt lgkmcnt(0)
s_add_u32 s20, s6, s15
s_addc_u32 s21, s7, 0
s_add_u32 s24, s8, s15
s_addc_u32 s25, s9, 0
s_add_u32 s16, s4, s14
s_addc_u32 s17, s5, 0
s_add_u32 s28, s10, s14
s_addc_u32 s29, s11, 0
s_mov_b32 m0, s34
s_nop 0
buffer_load_dwordx4 v226, s[20:23], s35 offen nt lds
s_add_u32 m0, s34, 4352
s_nop 0
buffer_load_dwordx4 v227, s[20:23], s35 offen nt lds
s_add_u32 m0, s34, s44
s_nop 0
buffer_load_dwordx4 v228, s[24:27], s35 offen nt lds
s_add_u32 m0, s34, s45
s_nop 0
buffer_load_dwordx4 v229, s[24:27], s35 offen nt lds
s_add_u32 s35, s35, 8192
s_add_u32 s34, s34, 17152
s_add_u32 m0, s48, 0
s_nop 0
buffer_load_dwordx4 v230, s[16:19], 0 offen offset:0 nt lds
s_add_u32 m0, s48, 64
s_nop 0
buffer_load_dwordx4 v230, s[16:19], 0 offen offset:1024 nt lds
s_add_u32 m0, s48, 128
s_nop 0
buffer_load_dwordx4 v230, s[16:19], 0 offen offset:2048 nt lds
s_add_u32 m0, s48, 192
s_nop 0
buffer_load_dwordx4 v230, s[16:19], 0 offen offset:3072 nt lds
v_add_u32 v230, 4096, v230
s_add_u32 m0, s48, 4352
s_nop 0
buffer_load_dwordx4 v230, s[16:19], 0 offen offset:0 nt lds
s_add_u32 m0, s48, 4416
s_nop 0
buffer_load_dwordx4 v230, s[16:19], 0 offen offset:1024 nt lds
s_add_u32 m0, s48, 4480
s_nop 0
buffer_load_dwordx4 v230, s[16:19], 0 offen offset:2048 nt lds
s_add_u32 m0, s48, 4544
s_nop 0
buffer_load_dwordx4 v230, s[16:19], 0 offen offset:3072 nt lds
v_add_u32 v230, 4096, v230
v_add_u32 v250, 16384, v250
v_min_u32 v250, L_fastend-L_pc, v250
v_mov_b32 v253, s53
v_add_co_u32 v252, vcc, s52, v250
s_nop 1
v_addc_co_u32 v253, vcc, 0, v253, vcc
global_load_dword v255, v[252:253], off
s_mov_b32 s38, 0x3e0293ee
s_mov_b32 s39, 0xffff0000
s_mov_b32 s54, 0x3e0293ee
s_mov_b32 s55, 0x3e0293ee
v_xor_b32 v10, v5, v7
v_lshlrev_b32 v10, 4, v10
v_lshl_add_u32 v10, v7, 8, v10
v_mul_u32_u24 v8, 1088, v3
v_add_u32 v224, v8, v10
v_and_b32 v8, 1, v5
v_lshl_add_u32 v8, v8, 2, v3
v_mul_u32_u24 v8, 1056, v8
v_lshrrev_b32 v11, 1, v5
v_lshl_add_u32 v8, v11, 8, v8
v_lshl_add_u32 v8, v7, 3, v8
v_add_u32 v225, 8704, v8
v_add_u32 v231, s47, v224
v_mov_b32 v216, 0
v_mov_b32 v217, 0
v_mov_b32 v218, 0
v_mov_b32 v219, 0
v_mov_b32 v220, 0
v_mov_b32 v221, 0
v_mov_b32 v222, 0
v_mov_b32 v223, 0
s_mov_b32 s42, 17152
s_add_u32 s51, s46, 68608
s_mov_b64 s[32:33], 0
s_waitcnt vmcnt(4)
ds_read_b128 v[232:235], v231 offset:0
ds_read_b128 v[236:239], v231 offset:64
ds_read_b128 v[240:243], v231 offset:128
ds_read_b128 v[244:247], v231 offset:192
s_barrier
ds_read_b128 a[128:131], v224 offset:0
ds_read_b128 a[132:135], v224 offset:64
ds_read_b128 a[136:139], v224 offset:128
ds_read_b128 a[140:143], v224 offset:192
ds_read_b128 a[144:147], v224 offset:4352
ds_read_b128 a[148:151], v224 offset:4416
ds_read_b128 a[152:155], v224 offset:4480
ds_read_b128 a[156:159], v224 offset:4544
s_mov_b32 m0, s34
s_nop 0
buffer_load_dwordx4 v226, s[20:23], s35 offen nt lds
s_add_u32 m0, s34, 4352
s_nop 0
buffer_load_dwordx4 v227, s[20:23], s35 offen nt lds
s_add_u32 m0, s34, s44
s_nop 0
buffer_load_dwordx4 v228, s[24:27], s35 offen nt lds
s_add_u32 m0, s34, s45
s_nop 0
buffer_load_dwordx4 v229, s[24:27], s35 offen nt lds
s_add_u32 s35, s35, 8192
s_add_u32 s34, s34, 17152
s_waitcnt lgkmcnt(8)
v_lshlrev_b32 v248, 16, v232
v_and_b32 v249, s39, v232
v_lshlrev_b32 v250, 16, v233
v_and_b32 v251, s39, v233
v_pk_mul_f32 v[248:249], v[248:249], s[54:55]
v_pk_mul_f32 v[250:251], v[250:251], s[54:55]
v_cvt_pk_bf16_f32 v248, v248, v249
v_cvt_pk_bf16_f32 v250, v250, v251
v_accvgpr_write_b32 a0, v248
v_accvgpr_write_b32 a1, v250
v_lshlrev_b32 v248, 16, v234
v_and_b32 v249, s39, v234
v_lshlrev_b32 v250, 16, v235
v_and_b32 v251, s39, v235
v_pk_mul_f32 v[248:249], v[248:249], s[54:55]
v_pk_mul_f32 v[250:251], v[250:251], s[54:55]
v_cvt_pk_bf16_f32 v248, v248, v249
v_cvt_pk_bf16_f32 v250, v250, v251
v_accvgpr_write_b32 a2, v248
v_accvgpr_write_b32 a3, v250
v_lshlrev_b32 v248, 16, v236
v_and_b32 v249, s39, v236
v_lshlrev_b32 v250, 16, v237
v_and_b32 v251, s39, v237
v_pk_mul_f32 v[248:249], v[248:249], s[54:55]
v_pk_mul_f32 v[250:251], v[250:251], s[54:55]
v_cvt_pk_bf16_f32 v248, v248, v249
v_cvt_pk_bf16_f32 v250, v250, v251
v_accvgpr_write_b32 a4, v248
v_accvgpr_write_b32 a5, v250
v_lshlrev_b32 v248, 16, v238
v_and_b32 v249, s39, v238
v_lshlrev_b32 v250, 16, v239
v_and_b32 v251, s39, v239
v_pk_mul_f32 v[248:249], v[248:249], s[54:55]
v_pk_mul_f32 v[250:251], v[250:251], s[54:55]
v_cvt_pk_bf16_f32 v248, v248, v249
v_cvt_pk_bf16_f32 v250, v250, v251
v_accvgpr_write_b32 a6, v248
v_accvgpr_write_b32 a7, v250
v_lshlrev_b32 v248, 16, v240
v_and_b32 v249, s39, v240
v_lshlrev_b32 v250, 16, v241
v_and_b32 v251, s39, v241
v_pk_mul_f32 v[248:249], v[248:249], s[54:55]
v_pk_mul_f32 v[250:251], v[250:251], s[54:55]
v_cvt_pk_bf16_f32 v248, v248, v249
v_cvt_pk_bf16_f32 v250, v250, v251
v_accvgpr_write_b32 a8, v248
v_accvgpr_write_b32 a9, v250
v_lshlrev_b32 v248, 16, v242
v_and_b32 v249, s39, v242
v_lshlrev_b32 v250, 16, v243
v_and_b32 v251, s39, v243
v_pk_mul_f32 v[248:249], v[248:249], s[54:55]
v_pk_mul_f32 v[250:251], v[250:251], s[54:55]
v_cvt_pk_bf16_f32 v248, v248, v249
v_cvt_pk_bf16_f32 v250, v250, v251
v_accvgpr_write_b32 a10, v248
v_accvgpr_write_b32 a11, v250
v_lshlrev_b32 v248, 16, v244
v_and_b32 v249, s39, v244
v_lshlrev_b32 v250, 16, v245
v_and_b32 v251, s39, v245
v_pk_mul_f32 v[248:249], v[248:249], s[54:55]
v_pk_mul_f32 v[250:251], v[250:251], s[54:55]
v_cvt_pk_bf16_f32 v248, v248, v249
v_cvt_pk_bf16_f32 v250, v250, v251
v_accvgpr_write_b32 a12, v248
v_accvgpr_write_b32 a13, v250
v_lshlrev_b32 v248, 16, v246
v_and_b32 v249, s39, v246
v_lshlrev_b32 v250, 16, v247
v_and_b32 v251, s39, v247
v_pk_mul_f32 v[248:249], v[248:249], s[54:55]
v_pk_mul_f32 v[250:251], v[250:251], s[54:55]
v_cvt_pk_bf16_f32 v248, v248, v249
v_cvt_pk_bf16_f32 v250, v250, v251
v_accvgpr_write_b32 a14, v248
v_accvgpr_write_b32 a15, v250
s_waitcnt lgkmcnt(0)
v_mfma_f32_16x16x32_bf16 v[192:195], a[128:131], a[0:3], 0
v_mfma_f32_16x16x32_bf16 v[192:195], a[132:135], a[4:7], v[192:195]
v_mfma_f32_16x16x32_bf16 v[192:195], a[136:139], a[8:11], v[192:195]
v_mfma_f32_16x16x32_bf16 v[192:195], a[140:143], a[12:15], v[192:195]
v_mfma_f32_16x16x32_bf16 v[196:199], a[144:147], a[0:3], 0
v_mfma_f32_16x16x32_bf16 v[196:199], a[148:151], a[4:7], v[196:199]
v_mfma_f32_16x16x32_bf16 v[196:199], a[152:155], a[8:11], v[196:199]
v_mfma_f32_16x16x32_bf16 v[196:199], a[156:159], a[12:15], v[196:199]
s_nop 3
v_exp_f32 v192, v192
ds_read_b64_tr_b16 a[160:161], v225 offset:0
v_add_f32 v216, v216, v192
ds_read_b64_tr_b16 a[162:163], v225 offset:512
v_exp_f32 v193, v193
ds_read_b64_tr_b16 a[164:165], v225 offset:32
v_cvt_pk_bf16_f32 v208, v192, v193
ds_read_b64_tr_b16 a[166:167], v225 offset:544
v_exp_f32 v194, v194
ds_read_b64_tr_b16 a[168:169], v225 offset:64
v_add_f32 v216, v216, v193
ds_read_b64_tr_b16 a[170:171], v225 offset:576
v_exp_f32 v195, v195
ds_read_b64_tr_b16 a[172:173], v225 offset:96
v_cvt_pk_bf16_f32 v209, v194, v195
ds_read_b64_tr_b16 a[174:175], v225 offset:608
v_exp_f32 v196, v196
s_waitcnt vmcnt(4)
ds_read_b128 v[232:235], v231 offset:4352
ds_read_b128 v[236:239], v231 offset:4416
ds_read_b128 v[240:243], v231 offset:4480
ds_read_b128 v[244:247], v231 offset:4544
s_add_u32 m0, s48, 8704
s_nop 0
buffer_load_dwordx4 v230, s[16:19], 0 offen offset:0 nt lds
s_add_u32 m0, s48, 8768
s_nop 0
buffer_load_dwordx4 v230, s[16:19], 0 offen offset:1024 nt lds
s_add_u32 m0, s48, 8832
s_nop 0
buffer_load_dwordx4 v230, s[16:19], 0 offen offset:2048 nt lds
s_add_u32 m0, s48, 8896
s_nop 0
buffer_load_dwordx4 v230, s[16:19], 0 offen offset:3072 nt lds
v_add_u32 v230, 4096, v230
s_waitcnt lgkmcnt(0)
v_lshlrev_b32 v248, 16, v232
v_and_b32 v249, s39, v232
v_lshlrev_b32 v250, 16, v233
v_and_b32 v251, s39, v233
v_pk_mul_f32 v[248:249], v[248:249], s[54:55]
v_pk_mul_f32 v[250:251], v[250:251], s[54:55]
v_cvt_pk_bf16_f32 v248, v248, v249
v_cvt_pk_bf16_f32 v250, v250, v251
v_accvgpr_write_b32 a16, v248
v_accvgpr_write_b32 a17, v250
v_lshlrev_b32 v248, 16, v234
v_and_b32 v249, s39, v234
v_lshlrev_b32 v250, 16, v235
v_and_b32 v251, s39, v235
v_pk_mul_f32 v[248:249], v[248:249], s[54:55]
v_pk_mul_f32 v[250:251], v[250:251], s[54:55]
v_cvt_pk_bf16_f32 v248, v248, v249
v_cvt_pk_bf16_f32 v250, v250, v251
v_accvgpr_write_b32 a18, v248
v_accvgpr_write_b32 a19, v250
v_lshlrev_b32 v248, 16, v236
v_and_b32 v249, s39, v236
v_lshlrev_b32 v250, 16, v237
v_and_b32 v251, s39, v237
v_pk_mul_f32 v[248:249], v[248:249], s[54:55]
v_pk_mul_f32 v[250:251], v[250:251], s[54:55]
v_cvt_pk_bf16_f32 v248, v248, v249
v_cvt_pk_bf16_f32 v250, v250, v251
v_accvgpr_write_b32 a20, v248
v_accvgpr_write_b32 a21, v250
v_lshlrev_b32 v248, 16, v238
v_and_b32 v249, s39, v238
v_lshlrev_b32 v250, 16, v239
v_and_b32 v251, s39, v239
v_pk_mul_f32 v[248:249], v[248:249], s[54:55]
v_pk_mul_f32 v[250:251], v[250:251], s[54:55]
v_cvt_pk_bf16_f32 v248, v248, v249
v_cvt_pk_bf16_f32 v250, v250, v251
v_accvgpr_write_b32 a22, v248
v_accvgpr_write_b32 a23, v250
v_lshlrev_b32 v248, 16, v240
v_and_b32 v249, s39, v240
v_lshlrev_b32 v250, 16, v241
v_and_b32 v251, s39, v241
v_pk_mul_f32 v[248:249], v[248:249], s[54:55]
v_pk_mul_f32 v[250:251], v[250:251], s[54:55]
v_cvt_pk_bf16_f32 v248, v248, v249
v_cvt_pk_bf16_f32 v250, v250, v251
v_accvgpr_write_b32 a24, v248
v_accvgpr_write_b32 a25, v250
v_lshlrev_b32 v248, 16, v242
v_and_b32 v249, s39, v242
v_lshlrev_b32 v250, 16, v243
v_and_b32 v251, s39, v243
v_pk_mul_f32 v[248:249], v[248:249], s[54:55]
v_pk_mul_f32 v[250:251], v[250:251], s[54:55]
v_cvt_pk_bf16_f32 v248, v248, v249
v_cvt_pk_bf16_f32 v250, v250, v251
v_accvgpr_write_b32 a26, v248
v_accvgpr_write_b32 a27, v250
v_lshlrev_b32 v248, 16, v244
v_and_b32 v249, s39, v244
v_lshlrev_b32 v250, 16, v245
v_and_b32 v251, s39, v245
v_pk_mul_f32 v[248:249], v[248:249], s[54:55]
v_pk_mul_f32 v[250:251], v[250:251], s[54:55]
v_cvt_pk_bf16_f32 v248, v248, v249
v_cvt_pk_bf16_f32 v250, v250, v251
v_accvgpr_write_b32 a28, v248
v_accvgpr_write_b32 a29, v250
v_lshlrev_b32 v248, 16, v246
v_and_b32 v249, s39, v246
v_lshlrev_b32 v250, 16, v247
v_and_b32 v251, s39, v247
v_pk_mul_f32 v[248:249], v[248:249], s[54:55]
v_pk_mul_f32 v[250:251], v[250:251], s[54:55]
v_cvt_pk_bf16_f32 v248, v248, v249
v_cvt_pk_bf16_f32 v250, v250, v251
v_accvgpr_write_b32 a30, v248
v_accvgpr_write_b32 a31, v250
v_mfma_f32_16x16x32_bf16 v[200:203], a[128:131], a[16:19], 0
ds_read_b64_tr_b16 a[176:177], v225 offset:128
v_add_f32 v216, v216, v194
v_mfma_f32_16x16x32_bf16 v[200:203], a[132:135], a[20:23], v[200:203]
ds_read_b64_tr_b16 a[178:179], v225 offset:640
v_exp_f32 v197, v197
v_mfma_f32_16x16x32_bf16 v[200:203], a[136:139], a[24:27], v[200:203]
ds_read_b64_tr_b16 a[180:181], v225 offset:160
v_cvt_pk_bf16_f32 v210, v196, v197
v_mfma_f32_16x16x32_bf16 v[200:203], a[140:143], a[28:31], v[200:203]
ds_read_b64_tr_b16 a[182:183], v225 offset:672
v_exp_f32 v198, v198
v_mfma_f32_16x16x32_bf16 v[204:207], a[144:147], a[16:19], 0
ds_read_b64_tr_b16 a[184:185], v225 offset:192
v_add_f32 v216, v216, v195
v_mfma_f32_16x16x32_bf16 v[204:207], a[148:151], a[20:23], v[204:207]
ds_read_b64_tr_b16 a[186:187], v225 offset:704
v_exp_f32 v199, v199
v_mfma_f32_16x16x32_bf16 v[204:207], a[152:155], a[24:27], v[204:207]
ds_read_b64_tr_b16 a[188:189], v225 offset:224
v_cvt_pk_bf16_f32 v211, v198, v199
v_mfma_f32_16x16x32_bf16 v[204:207], a[156:159], a[28:31], v[204:207]
s_waitcnt lgkmcnt(11)
ds_read_b64_tr_b16 a[190:191], v225 offset:736
v_exp_f32 v200, v200
v_mfma_f32_16x16x32_bf16 a[192:195], a[160:163], v[208:211], 0
v_add_f32 v216, v216, v196
v_add_f32 v216, v216, v197
v_mfma_f32_16x16x32_bf16 a[196:199], a[164:167], v[208:211], 0
v_exp_f32 v201, v201
v_mfma_f32_16x16x32_bf16 a[200:203], a[168:171], v[208:211], 0
v_cvt_pk_bf16_f32 v212, v200, v201
v_add_f32 v216, v216, v198
v_mfma_f32_16x16x32_bf16 a[204:207], a[172:175], v[208:211], 0
s_waitcnt lgkmcnt(4)
v_exp_f32 v202, v202
v_mfma_f32_16x16x32_bf16 a[208:211], a[176:179], v[208:211], 0
v_add_f32 v216, v216, v199
v_add_f32 v217, v217, v200
v_mfma_f32_16x16x32_bf16 a[212:215], a[180:183], v[208:211], 0
s_waitcnt lgkmcnt(0)
v_exp_f32 v203, v203
v_mfma_f32_16x16x32_bf16 a[216:219], a[184:187], v[208:211], 0
v_cvt_pk_bf16_f32 v213, v202, v203
v_add_f32 v217, v217, v201
v_mfma_f32_16x16x32_bf16 a[220:223], a[188:191], v[208:211], 0
v_exp_f32 v204, v204
s_waitcnt vmcnt(4)
s_barrier
ds_read_b128 a[128:131], v224 offset:17152
ds_read_b128 a[132:135], v224 offset:17216
ds_read_b128 a[136:139], v224 offset:17280
ds_read_b128 a[140:143], v224 offset:17344
ds_read_b128 a[144:147], v224 offset:21504
ds_read_b128 a[148:151], v224 offset:21568
ds_read_b128 a[152:155], v224 offset:21632
ds_read_b128 a[156:159], v224 offset:21696
s_add_u32 m0, s48, 13056
s_nop 0
buffer_load_dwordx4 v230, s[16:19], 0 offen offset:0 nt lds
s_add_u32 m0, s48, 13120
s_nop 0
buffer_load_dwordx4 v230, s[16:19], 0 offen offset:1024 nt lds
s_add_u32 m0, s48, 13184
s_nop 0
buffer_load_dwordx4 v230, s[16:19], 0 offen offset:2048 nt lds
s_add_u32 m0, s48, 13248
s_nop 0
buffer_load_dwordx4 v230, s[16:19], 0 offen offset:3072 nt lds
v_add_u32 v230, 4096, v230
s_waitcnt lgkmcnt(0)
v_mfma_f32_16x16x32_bf16 v[192:195], a[128:131], a[0:3], 0
v_add_f32 v217, v217, v202
v_add_f32 v217, v217, v203
v_mfma_f32_16x16x32_bf16 v[192:195], a[132:135], a[4:7], v[192:195]
v_exp_f32 v205, v205
v_mfma_f32_16x16x32_bf16 v[192:195], a[136:139], a[8:11], v[192:195]
v_cvt_pk_bf16_f32 v214, v204, v205
v_add_f32 v217, v217, v204
v_mfma_f32_16x16x32_bf16 v[192:195], a[140:143], a[12:15], v[192:195]
v_exp_f32 v206, v206
v_mfma_f32_16x16x32_bf16 v[196:199], a[144:147], a[0:3], 0
v_add_f32 v217, v217, v205
v_add_f32 v217, v217, v206
v_mfma_f32_16x16x32_bf16 v[196:199], a[148:151], a[4:7], v[196:199]
v_exp_f32 v207, v207
v_mfma_f32_16x16x32_bf16 v[196:199], a[152:155], a[8:11], v[196:199]
v_cvt_pk_bf16_f32 v215, v206, v207
v_add_f32 v217, v217, v207
v_mfma_f32_16x16x32_bf16 v[196:199], a[156:159], a[12:15], v[196:199]
v_exp_f32 v192, v192
v_mfma_f32_16x16x32_bf16 a[224:227], a[160:163], v[212:215], 0
ds_read_b64_tr_b16 a[160:161], v225 offset:17152
v_add_f32 v216, v216, v192
v_mfma_f32_16x16x32_bf16 a[228:231], a[164:167], v[212:215], 0
ds_read_b64_tr_b16 a[162:163], v225 offset:17664
v_exp_f32 v193, v193
v_mfma_f32_16x16x32_bf16 a[232:235], a[168:171], v[212:215], 0
ds_read_b64_tr_b16 a[164:165], v225 offset:17184
v_cvt_pk_bf16_f32 v208, v192, v193
v_mfma_f32_16x16x32_bf16 a[236:239], a[172:175], v[212:215], 0
ds_read_b64_tr_b16 a[166:167], v225 offset:17696
v_exp_f32 v194, v194
v_mfma_f32_16x16x32_bf16 a[240:243], a[176:179], v[212:215], 0
ds_read_b64_tr_b16 a[168:169], v225 offset:17216
v_add_f32 v216, v216, v193
v_mfma_f32_16x16x32_bf16 a[244:247], a[180:183], v[212:215], 0
ds_read_b64_tr_b16 a[170:171], v225 offset:17728
v_exp_f32 v195, v195
v_mfma_f32_16x16x32_bf16 a[248:251], a[184:187], v[212:215], 0
ds_read_b64_tr_b16 a[172:173], v225 offset:17248
v_cvt_pk_bf16_f32 v209, v194, v195
v_mfma_f32_16x16x32_bf16 a[252:255], a[188:191], v[212:215], 0
ds_read_b64_tr_b16 a[174:175], v225 offset:17760
v_exp_f32 v196, v196
v_mfma_f32_16x16x32_bf16 v[200:203], a[128:131], a[16:19], 0
ds_read_b64_tr_b16 a[176:177], v225 offset:17280
v_add_f32 v216, v216, v194
v_mfma_f32_16x16x32_bf16 v[200:203], a[132:135], a[20:23], v[200:203]
ds_read_b64_tr_b16 a[178:179], v225 offset:17792
v_exp_f32 v197, v197
v_mfma_f32_16x16x32_bf16 v[200:203], a[136:139], a[24:27], v[200:203]
ds_read_b64_tr_b16 a[180:181], v225 offset:17312
v_cvt_pk_bf16_f32 v210, v196, v197
v_mfma_f32_16x16x32_bf16 v[200:203], a[140:143], a[28:31], v[200:203]
ds_read_b64_tr_b16 a[182:183], v225 offset:17824
v_exp_f32 v198, v198
v_mfma_f32_16x16x32_bf16 v[204:207], a[144:147], a[16:19], 0
ds_read_b64_tr_b16 a[184:185], v225 offset:17344
v_add_f32 v216, v216, v195
v_mfma_f32_16x16x32_bf16 v[204:207], a[148:151], a[20:23], v[204:207]
ds_read_b64_tr_b16 a[186:187], v225 offset:17856
v_exp_f32 v199, v199
v_mfma_f32_16x16x32_bf16 v[204:207], a[152:155], a[24:27], v[204:207]
ds_read_b64_tr_b16 a[188:189], v225 offset:17376
v_cvt_pk_bf16_f32 v211, v198, v199
v_mfma_f32_16x16x32_bf16 v[204:207], a[156:159], a[28:31], v[204:207]
s_waitcnt lgkmcnt(7)
ds_read_b64_tr_b16 a[190:191], v225 offset:17888
v_exp_f32 v200, v200
v_mfma_f32_16x16x32_bf16 a[192:195], a[160:163], v[208:211], a[192:195]
v_add_f32 v216, v216, v196
v_add_f32 v216, v216, v197
v_mfma_f32_16x16x32_bf16 a[196:199], a[164:167], v[208:211], a[196:199]
v_exp_f32 v201, v201
v_mfma_f32_16x16x32_bf16 a[200:203], a[168:171], v[208:211], a[200:203]
v_cvt_pk_bf16_f32 v212, v200, v201
v_add_f32 v216, v216, v198
v_mfma_f32_16x16x32_bf16 a[204:207], a[172:175], v[208:211], a[204:207]
s_waitcnt lgkmcnt(4)
v_exp_f32 v202, v202
v_mfma_f32_16x16x32_bf16 a[208:211], a[176:179], v[208:211], a[208:211]
v_add_f32 v216, v216, v199
v_add_f32 v217, v217, v200
v_mfma_f32_16x16x32_bf16 a[212:215], a[180:183], v[208:211], a[212:215]
s_waitcnt lgkmcnt(0)
v_exp_f32 v203, v203
v_mfma_f32_16x16x32_bf16 a[216:219], a[184:187], v[208:211], a[216:219]
v_cvt_pk_bf16_f32 v213, v202, v203
v_add_f32 v217, v217, v201
v_mfma_f32_16x16x32_bf16 a[220:223], a[188:191], v[208:211], a[220:223]
v_exp_f32 v204, v204
s_waitcnt vmcnt(4)
ds_read_b128 v[232:235], v231 offset:8704
ds_read_b128 v[236:239], v231 offset:8768
ds_read_b128 v[240:243], v231 offset:8832
ds_read_b128 v[244:247], v231 offset:8896
s_add_u32 m0, s48, 0
s_nop 0
buffer_load_dwordx4 v230, s[16:19], 0 offen offset:0 nt lds
s_add_u32 m0, s48, 64
s_nop 0
buffer_load_dwordx4 v230, s[16:19], 0 offen offset:1024 nt lds
s_add_u32 m0, s48, 128
s_nop 0
buffer_load_dwordx4 v230, s[16:19], 0 offen offset:2048 nt lds
s_add_u32 m0, s48, 192
s_nop 0
buffer_load_dwordx4 v230, s[16:19], 0 offen offset:3072 nt lds
v_add_u32 v230, 4096, v230
s_waitcnt lgkmcnt(0)
v_lshlrev_b32 v248, 16, v232
v_and_b32 v249, s39, v232
v_lshlrev_b32 v250, 16, v233
v_and_b32 v251, s39, v233
v_pk_mul_f32 v[248:249], v[248:249], s[54:55]
v_pk_mul_f32 v[250:251], v[250:251], s[54:55]
v_cvt_pk_bf16_f32 v248, v248, v249
v_cvt_pk_bf16_f32 v250, v250, v251
v_accvgpr_write_b32 a32, v248
v_accvgpr_write_b32 a33, v250
v_lshlrev_b32 v248, 16, v234
v_and_b32 v249, s39, v234
v_lshlrev_b32 v250, 16, v235
v_and_b32 v251, s39, v235
v_pk_mul_f32 v[248:249], v[248:249], s[54:55]
v_pk_mul_f32 v[250:251], v[250:251], s[54:55]
v_cvt_pk_bf16_f32 v248, v248, v249
v_cvt_pk_bf16_f32 v250, v250, v251
v_accvgpr_write_b32 a34, v248
v_accvgpr_write_b32 a35, v250
v_lshlrev_b32 v248, 16, v236
v_and_b32 v249, s39, v236
v_lshlrev_b32 v250, 16, v237
v_and_b32 v251, s39, v237
v_pk_mul_f32 v[248:249], v[248:249], s[54:55]
v_pk_mul_f32 v[250:251], v[250:251], s[54:55]
v_cvt_pk_bf16_f32 v248, v248, v249
v_cvt_pk_bf16_f32 v250, v250, v251
v_accvgpr_write_b32 a36, v248
v_accvgpr_write_b32 a37, v250
v_lshlrev_b32 v248, 16, v238
v_and_b32 v249, s39, v238
v_lshlrev_b32 v250, 16, v239
v_and_b32 v251, s39, v239
v_pk_mul_f32 v[248:249], v[248:249], s[54:55]
v_pk_mul_f32 v[250:251], v[250:251], s[54:55]
v_cvt_pk_bf16_f32 v248, v248, v249
v_cvt_pk_bf16_f32 v250, v250, v251
v_accvgpr_write_b32 a38, v248
v_accvgpr_write_b32 a39, v250
v_lshlrev_b32 v248, 16, v240
v_and_b32 v249, s39, v240
v_lshlrev_b32 v250, 16, v241
v_and_b32 v251, s39, v241
v_pk_mul_f32 v[248:249], v[248:249], s[54:55]
v_pk_mul_f32 v[250:251], v[250:251], s[54:55]
v_cvt_pk_bf16_f32 v248, v248, v249
v_cvt_pk_bf16_f32 v250, v250, v251
v_accvgpr_write_b32 a40, v248
v_accvgpr_write_b32 a41, v250
v_lshlrev_b32 v248, 16, v242
v_and_b32 v249, s39, v242
v_lshlrev_b32 v250, 16, v243
v_and_b32 v251, s39, v243
v_pk_mul_f32 v[248:249], v[248:249], s[54:55]
v_pk_mul_f32 v[250:251], v[250:251], s[54:55]
v_cvt_pk_bf16_f32 v248, v248, v249
v_cvt_pk_bf16_f32 v250, v250, v251
v_accvgpr_write_b32 a42, v248
v_accvgpr_write_b32 a43, v250
v_lshlrev_b32 v248, 16, v244
v_and_b32 v249, s39, v244
v_lshlrev_b32 v250, 16, v245
v_and_b32 v251, s39, v245
v_pk_mul_f32 v[248:249], v[248:249], s[54:55]
v_pk_mul_f32 v[250:251], v[250:251], s[54:55]
v_cvt_pk_bf16_f32 v248, v248, v249
v_cvt_pk_bf16_f32 v250, v250, v251
v_accvgpr_write_b32 a44, v248
v_accvgpr_write_b32 a45, v250
v_lshlrev_b32 v248, 16, v246
v_and_b32 v249, s39, v246
v_lshlrev_b32 v250, 16, v247
v_and_b32 v251, s39, v247
v_pk_mul_f32 v[248:249], v[248:249], s[54:55]
v_pk_mul_f32 v[250:251], v[250:251], s[54:55]
v_cvt_pk_bf16_f32 v248, v248, v249
v_cvt_pk_bf16_f32 v250, v250, v251
v_accvgpr_write_b32 a46, v248
v_accvgpr_write_b32 a47, v250
v_mfma_f32_16x16x32_bf16 v[192:195], a[128:131], a[32:35], 0
v_add_f32 v217, v217, v202
v_add_f32 v217, v217, v203
v_mfma_f32_16x16x32_bf16 v[192:195], a[132:135], a[36:39], v[192:195]
v_exp_f32 v205, v205
v_mfma_f32_16x16x32_bf16 v[192:195], a[136:139], a[40:43], v[192:195]
v_cvt_pk_bf16_f32 v214, v204, v205
v_add_f32 v217, v217, v204
v_mfma_f32_16x16x32_bf16 v[192:195], a[140:143], a[44:47], v[192:195]
v_exp_f32 v206, v206
v_mfma_f32_16x16x32_bf16 v[196:199], a[144:147], a[32:35], 0
v_add_f32 v217, v217, v205
v_add_f32 v217, v217, v206
v_mfma_f32_16x16x32_bf16 v[196:199], a[148:151], a[36:39], v[196:199]
v_exp_f32 v207, v207
v_mfma_f32_16x16x32_bf16 v[196:199], a[152:155], a[40:43], v[196:199]
v_cvt_pk_bf16_f32 v215, v206, v207
v_add_f32 v217, v217, v207
v_mfma_f32_16x16x32_bf16 v[196:199], a[156:159], a[44:47], v[196:199]
v_exp_f32 v192, v192
v_mfma_f32_16x16x32_bf16 a[224:227], a[160:163], v[212:215], a[224:227]
v_add_f32 v218, v218, v192
v_mfma_f32_16x16x32_bf16 a[228:231], a[164:167], v[212:215], a[228:231]
v_exp_f32 v193, v193
v_mfma_f32_16x16x32_bf16 a[232:235], a[168:171], v[212:215], a[232:235]
v_cvt_pk_bf16_f32 v208, v192, v193
v_add_f32 v218, v218, v193
v_mfma_f32_16x16x32_bf16 a[236:239], a[172:175], v[212:215], a[236:239]
v_exp_f32 v194, v194
v_mfma_f32_16x16x32_bf16 a[240:243], a[176:179], v[212:215], a[240:243]
v_add_f32 v218, v218, v194
v_mfma_f32_16x16x32_bf16 a[244:247], a[180:183], v[212:215], a[244:247]
v_exp_f32 v195, v195
v_mfma_f32_16x16x32_bf16 a[248:251], a[184:187], v[212:215], a[248:251]
v_cvt_pk_bf16_f32 v209, v194, v195
v_add_f32 v218, v218, v195
v_mfma_f32_16x16x32_bf16 a[252:255], a[188:191], v[212:215], a[252:255]
v_exp_f32 v196, v196
s_waitcnt vmcnt(4)
ds_read_b128 v[232:235], v231 offset:13056
ds_read_b128 v[236:239], v231 offset:13120
ds_read_b128 v[240:243], v231 offset:13184
ds_read_b128 v[244:247], v231 offset:13248
s_add_u32 m0, s48, 4352
s_nop 0
buffer_load_dwordx4 v230, s[16:19], 0 offen offset:0 nt lds
s_add_u32 m0, s48, 4416
s_nop 0
buffer_load_dwordx4 v230, s[16:19], 0 offen offset:1024 nt lds
s_add_u32 m0, s48, 4480
s_nop 0
buffer_load_dwordx4 v230, s[16:19], 0 offen offset:2048 nt lds
s_add_u32 m0, s48, 4544
s_nop 0
buffer_load_dwordx4 v230, s[16:19], 0 offen offset:3072 nt lds
v_add_u32 v230, 4096, v230
s_waitcnt lgkmcnt(0)
v_lshlrev_b32 v248, 16, v232
v_and_b32 v249, s39, v232
v_lshlrev_b32 v250, 16, v233
v_and_b32 v251, s39, v233
v_pk_mul_f32 v[248:249], v[248:249], s[54:55]
v_pk_mul_f32 v[250:251], v[250:251], s[54:55]
v_cvt_pk_bf16_f32 v248, v248, v249
v_cvt_pk_bf16_f32 v250, v250, v251
v_accvgpr_write_b32 a48, v248
v_accvgpr_write_b32 a49, v250
v_lshlrev_b32 v248, 16, v234
v_and_b32 v249, s39, v234
v_lshlrev_b32 v250, 16, v235
v_and_b32 v251, s39, v235
v_pk_mul_f32 v[248:249], v[248:249], s[54:55]
v_pk_mul_f32 v[250:251], v[250:251], s[54:55]
v_cvt_pk_bf16_f32 v248, v248, v249
v_cvt_pk_bf16_f32 v250, v250, v251
v_accvgpr_write_b32 a50, v248
v_accvgpr_write_b32 a51, v250
v_lshlrev_b32 v248, 16, v236
v_and_b32 v249, s39, v236
v_lshlrev_b32 v250, 16, v237
v_and_b32 v251, s39, v237
v_pk_mul_f32 v[248:249], v[248:249], s[54:55]
v_pk_mul_f32 v[250:251], v[250:251], s[54:55]
v_cvt_pk_bf16_f32 v248, v248, v249
v_cvt_pk_bf16_f32 v250, v250, v251
v_accvgpr_write_b32 a52, v248
v_accvgpr_write_b32 a53, v250
v_lshlrev_b32 v248, 16, v238
v_and_b32 v249, s39, v238
v_lshlrev_b32 v250, 16, v239
v_and_b32 v251, s39, v239
v_pk_mul_f32 v[248:249], v[248:249], s[54:55]
v_pk_mul_f32 v[250:251], v[250:251], s[54:55]
v_cvt_pk_bf16_f32 v248, v248, v249
v_cvt_pk_bf16_f32 v250, v250, v251
v_accvgpr_write_b32 a54, v248
v_accvgpr_write_b32 a55, v250
v_lshlrev_b32 v248, 16, v240
v_and_b32 v249, s39, v240
v_lshlrev_b32 v250, 16, v241
v_and_b32 v251, s39, v241
v_pk_mul_f32 v[248:249], v[248:249], s[54:55]
v_pk_mul_f32 v[250:251], v[250:251], s[54:55]
v_cvt_pk_bf16_f32 v248, v248, v249
v_cvt_pk_bf16_f32 v250, v250, v251
v_accvgpr_write_b32 a56, v248
v_accvgpr_write_b32 a57, v250
v_lshlrev_b32 v248, 16, v242
v_and_b32 v249, s39, v242
v_lshlrev_b32 v250, 16, v243
v_and_b32 v251, s39, v243
v_pk_mul_f32 v[248:249], v[248:249], s[54:55]
v_pk_mul_f32 v[250:251], v[250:251], s[54:55]
v_cvt_pk_bf16_f32 v248, v248, v249
v_cvt_pk_bf16_f32 v250, v250, v251
v_accvgpr_write_b32 a58, v248
v_accvgpr_write_b32 a59, v250
v_lshlrev_b32 v248, 16, v244
v_and_b32 v249, s39, v244
v_lshlrev_b32 v250, 16, v245
v_and_b32 v251, s39, v245
v_pk_mul_f32 v[248:249], v[248:249], s[54:55]
v_pk_mul_f32 v[250:251], v[250:251], s[54:55]
v_cvt_pk_bf16_f32 v248, v248, v249
v_cvt_pk_bf16_f32 v250, v250, v251
v_accvgpr_write_b32 a60, v248
v_accvgpr_write_b32 a61, v250
v_lshlrev_b32 v248, 16, v246
v_and_b32 v249, s39, v246
v_lshlrev_b32 v250, 16, v247
v_and_b32 v251, s39, v247
v_pk_mul_f32 v[248:249], v[248:249], s[54:55]
v_pk_mul_f32 v[250:251], v[250:251], s[54:55]
v_cvt_pk_bf16_f32 v248, v248, v249
v_cvt_pk_bf16_f32 v250, v250, v251
v_accvgpr_write_b32 a62, v248
v_accvgpr_write_b32 a63, v250
v_mfma_f32_16x16x32_bf16 v[200:203], a[128:131], a[48:51], 0
ds_read_b128 a[128:131], v224 offset:0
v_add_f32 v218, v218, v196
v_mfma_f32_16x16x32_bf16 v[200:203], a[132:135], a[52:55], v[200:203]
v_exp_f32 v197, v197
v_mfma_f32_16x16x32_bf16 v[200:203], a[136:139], a[56:59], v[200:203]
ds_read_b128 a[132:135], v224 offset:64
v_cvt_pk_bf16_f32 v210, v196, v197
v_mfma_f32_16x16x32_bf16 v[200:203], a[140:143], a[60:63], v[200:203]
v_exp_f32 v198, v198
v_mfma_f32_16x16x32_bf16 v[204:207], a[144:147], a[48:51], 0
ds_read_b128 a[136:139], v224 offset:128
v_add_f32 v218, v218, v197
v_mfma_f32_16x16x32_bf16 v[204:207], a[148:151], a[52:55], v[204:207]
v_exp_f32 v199, v199
v_mfma_f32_16x16x32_bf16 v[204:207], a[152:155], a[56:59], v[204:207]
ds_read_b128 a[140:143], v224 offset:192
v_cvt_pk_bf16_f32 v211, v198, v199
v_mfma_f32_16x16x32_bf16 v[204:207], a[156:159], a[60:63], v[204:207]
v_exp_f32 v200, v200
v_mfma_f32_16x16x32_bf16 v[0:3], a[160:163], v[208:211], 0
ds_read_b128 a[144:147], v224 offset:4352
v_add_f32 v218, v218, v198
v_mfma_f32_16x16x32_bf16 v[4:7], a[164:167], v[208:211], 0
v_exp_f32 v201, v201
v_mfma_f32_16x16x32_bf16 v[8:11], a[168:171], v[208:211], 0
ds_read_b128 a[148:151], v224 offset:4416
v_cvt_pk_bf16_f32 v212, v200, v201
v_mfma_f32_16x16x32_bf16 v[12:15], a[172:175], v[208:211], 0
v_exp_f32 v202, v202
v_mfma_f32_16x16x32_bf16 v[16:19], a[176:179], v[208:211], 0
ds_read_b128 a[152:155], v224 offset:4480
v_add_f32 v218, v218, v199
v_mfma_f32_16x16x32_bf16 v[20:23], a[180:183], v[208:211], 0
s_waitcnt lgkmcnt(3)
v_exp_f32 v203, v203
v_mfma_f32_16x16x32_bf16 v[24:27], a[184:187], v[208:211], 0
ds_read_b128 a[156:159], v224 offset:4544
v_cvt_pk_bf16_f32 v213, v202, v203
v_mfma_f32_16x16x32_bf16 v[28:31], a[188:191], v[208:211], 0
v_exp_f32 v204, v204
v_mfma_f32_16x16x32_bf16 v[192:195], a[128:131], a[32:35], 0
v_add_f32 v219, v219, v200
v_add_f32 v219, v219, v201
v_mfma_f32_16x16x32_bf16 v[192:195], a[132:135], a[36:39], v[192:195]
v_exp_f32 v205, v205
v_mfma_f32_16x16x32_bf16 v[192:195], a[136:139], a[40:43], v[192:195]
v_cvt_pk_bf16_f32 v214, v204, v205
v_add_f32 v219, v219, v202
v_mfma_f32_16x16x32_bf16 v[192:195], a[140:143], a[44:47], v[192:195]
s_waitcnt lgkmcnt(1)
v_exp_f32 v206, v206
v_mfma_f32_16x16x32_bf16 v[196:199], a[144:147], a[32:35], 0
v_add_f32 v219, v219, v203
v_add_f32 v219, v219, v204
v_mfma_f32_16x16x32_bf16 v[196:199], a[148:151], a[36:39], v[196:199]
v_exp_f32 v207, v207
v_mfma_f32_16x16x32_bf16 v[196:199], a[152:155], a[40:43], v[196:199]
s_waitcnt lgkmcnt(0)
v_cvt_pk_bf16_f32 v215, v206, v207
v_add_f32 v219, v219, v205
v_mfma_f32_16x16x32_bf16 v[196:199], a[156:159], a[44:47], v[196:199]
v_exp_f32 v192, v192
v_mfma_f32_16x16x32_bf16 v[32:35], a[160:163], v[212:215], 0
ds_read_b64_tr_b16 a[160:161], v225 offset:0
v_add_f32 v219, v219, v206
v_mfma_f32_16x16x32_bf16 v[36:39], a[164:167], v[212:215], 0
ds_read_b64_tr_b16 a[162:163], v225 offset:512
v_exp_f32 v193, v193
v_mfma_f32_16x16x32_bf16 v[40:43], a[168:171], v[212:215], 0
ds_read_b64_tr_b16 a[164:165], v225 offset:32
v_cvt_pk_bf16_f32 v208, v192, v193
v_mfma_f32_16x16x32_bf16 v[44:47], a[172:175], v[212:215], 0
ds_read_b64_tr_b16 a[166:167], v225 offset:544
v_exp_f32 v194, v194
v_mfma_f32_16x16x32_bf16 v[48:51], a[176:179], v[212:215], 0
ds_read_b64_tr_b16 a[168:169], v225 offset:64
v_add_f32 v219, v219, v207
v_mfma_f32_16x16x32_bf16 v[52:55], a[180:183], v[212:215], 0
ds_read_b64_tr_b16 a[170:171], v225 offset:576
v_exp_f32 v195, v195
v_mfma_f32_16x16x32_bf16 v[56:59], a[184:187], v[212:215], 0
ds_read_b64_tr_b16 a[172:173], v225 offset:96
v_cvt_pk_bf16_f32 v209, v194, v195
v_mfma_f32_16x16x32_bf16 v[60:63], a[188:191], v[212:215], 0
ds_read_b64_tr_b16 a[174:175], v225 offset:608
v_exp_f32 v196, v196
v_mfma_f32_16x16x32_bf16 v[200:203], a[128:131], a[48:51], 0
ds_read_b64_tr_b16 a[176:177], v225 offset:128
v_add_f32 v218, v218, v192
v_mfma_f32_16x16x32_bf16 v[200:203], a[132:135], a[52:55], v[200:203]
ds_read_b64_tr_b16 a[178:179], v225 offset:640
v_exp_f32 v197, v197
v_mfma_f32_16x16x32_bf16 v[200:203], a[136:139], a[56:59], v[200:203]
ds_read_b64_tr_b16 a[180:181], v225 offset:160
v_cvt_pk_bf16_f32 v210, v196, v197
v_mfma_f32_16x16x32_bf16 v[200:203], a[140:143], a[60:63], v[200:203]
ds_read_b64_tr_b16 a[182:183], v225 offset:672
v_exp_f32 v198, v198
v_mfma_f32_16x16x32_bf16 v[204:207], a[144:147], a[48:51], 0
ds_read_b64_tr_b16 a[184:185], v225 offset:192
v_add_f32 v218, v218, v193
v_mfma_f32_16x16x32_bf16 v[204:207], a[148:151], a[52:55], v[204:207]
ds_read_b64_tr_b16 a[186:187], v225 offset:704
v_exp_f32 v199, v199
v_mfma_f32_16x16x32_bf16 v[204:207], a[152:155], a[56:59], v[204:207]
ds_read_b64_tr_b16 a[188:189], v225 offset:224
v_cvt_pk_bf16_f32 v211, v198, v199
v_mfma_f32_16x16x32_bf16 v[204:207], a[156:159], a[60:63], v[204:207]
s_waitcnt lgkmcnt(7)
ds_read_b64_tr_b16 a[190:191], v225 offset:736
v_exp_f32 v200, v200
v_mfma_f32_16x16x32_bf16 v[0:3], a[160:163], v[208:211], v[0:3]
v_add_f32 v218, v218, v194
v_add_f32 v218, v218, v195
v_mfma_f32_16x16x32_bf16 v[4:7], a[164:167], v[208:211], v[4:7]
v_exp_f32 v201, v201
v_mfma_f32_16x16x32_bf16 v[8:11], a[168:171], v[208:211], v[8:11]
v_cvt_pk_bf16_f32 v212, v200, v201
v_add_f32 v218, v218, v196
v_mfma_f32_16x16x32_bf16 v[12:15], a[172:175], v[208:211], v[12:15]
s_waitcnt lgkmcnt(4)
v_exp_f32 v202, v202
v_mfma_f32_16x16x32_bf16 v[16:19], a[176:179], v[208:211], v[16:19]
v_add_f32 v218, v218, v197
v_add_f32 v218, v218, v198
v_mfma_f32_16x16x32_bf16 v[20:23], a[180:183], v[208:211], v[20:23]
s_waitcnt lgkmcnt(0)
v_exp_f32 v203, v203
v_mfma_f32_16x16x32_bf16 v[24:27], a[184:187], v[208:211], v[24:27]
v_cvt_pk_bf16_f32 v213, v202, v203
v_add_f32 v218, v218, v199
v_mfma_f32_16x16x32_bf16 v[28:31], a[188:191], v[208:211], v[28:31]
v_exp_f32 v204, v204
s_waitcnt vmcnt(4)
ds_read_b128 v[232:235], v231 offset:0
ds_read_b128 v[236:239], v231 offset:64
ds_read_b128 v[240:243], v231 offset:128
ds_read_b128 v[244:247], v231 offset:192
s_add_u32 m0, s48, 8704
s_nop 0
buffer_load_dwordx4 v230, s[16:19], 0 offen offset:0 nt lds
s_add_u32 m0, s48, 8768
s_nop 0
buffer_load_dwordx4 v230, s[16:19], 0 offen offset:1024 nt lds
s_add_u32 m0, s48, 8832
s_nop 0
buffer_load_dwordx4 v230, s[16:19], 0 offen offset:2048 nt lds
s_add_u32 m0, s48, 8896
s_nop 0
buffer_load_dwordx4 v230, s[16:19], 0 offen offset:3072 nt lds
v_add_u32 v230, 4096, v230
s_waitcnt lgkmcnt(0)
v_lshlrev_b32 v248, 16, v232
v_and_b32 v249, s39, v232
v_lshlrev_b32 v250, 16, v233
v_and_b32 v251, s39, v233
v_pk_mul_f32 v[248:249], v[248:249], s[54:55]
v_pk_mul_f32 v[250:251], v[250:251], s[54:55]
v_cvt_pk_bf16_f32 v248, v248, v249
v_cvt_pk_bf16_f32 v250, v250, v251
v_accvgpr_write_b32 a64, v248
v_accvgpr_write_b32 a65, v250
v_lshlrev_b32 v248, 16, v234
v_and_b32 v249, s39, v234
v_lshlrev_b32 v250, 16, v235
v_and_b32 v251, s39, v235
v_pk_mul_f32 v[248:249], v[248:249], s[54:55]
v_pk_mul_f32 v[250:251], v[250:251], s[54:55]
v_cvt_pk_bf16_f32 v248, v248, v249
v_cvt_pk_bf16_f32 v250, v250, v251
v_accvgpr_write_b32 a66, v248
v_accvgpr_write_b32 a67, v250
v_lshlrev_b32 v248, 16, v236
v_and_b32 v249, s39, v236
v_lshlrev_b32 v250, 16, v237
v_and_b32 v251, s39, v237
v_pk_mul_f32 v[248:249], v[248:249], s[54:55]
v_pk_mul_f32 v[250:251], v[250:251], s[54:55]
v_cvt_pk_bf16_f32 v248, v248, v249
v_cvt_pk_bf16_f32 v250, v250, v251
v_accvgpr_write_b32 a68, v248
v_accvgpr_write_b32 a69, v250
v_lshlrev_b32 v248, 16, v238
v_and_b32 v249, s39, v238
v_lshlrev_b32 v250, 16, v239
v_and_b32 v251, s39, v239
v_pk_mul_f32 v[248:249], v[248:249], s[54:55]
v_pk_mul_f32 v[250:251], v[250:251], s[54:55]
v_cvt_pk_bf16_f32 v248, v248, v249
v_cvt_pk_bf16_f32 v250, v250, v251
v_accvgpr_write_b32 a70, v248
v_accvgpr_write_b32 a71, v250
v_lshlrev_b32 v248, 16, v240
v_and_b32 v249, s39, v240
v_lshlrev_b32 v250, 16, v241
v_and_b32 v251, s39, v241
v_pk_mul_f32 v[248:249], v[248:249], s[54:55]
v_pk_mul_f32 v[250:251], v[250:251], s[54:55]
v_cvt_pk_bf16_f32 v248, v248, v249
v_cvt_pk_bf16_f32 v250, v250, v251
v_accvgpr_write_b32 a72, v248
v_accvgpr_write_b32 a73, v250
v_lshlrev_b32 v248, 16, v242
v_and_b32 v249, s39, v242
v_lshlrev_b32 v250, 16, v243
v_and_b32 v251, s39, v243
v_pk_mul_f32 v[248:249], v[248:249], s[54:55]
v_pk_mul_f32 v[250:251], v[250:251], s[54:55]
v_cvt_pk_bf16_f32 v248, v248, v249
v_cvt_pk_bf16_f32 v250, v250, v251
v_accvgpr_write_b32 a74, v248
v_accvgpr_write_b32 a75, v250
v_lshlrev_b32 v248, 16, v244
v_and_b32 v249, s39, v244
v_lshlrev_b32 v250, 16, v245
v_and_b32 v251, s39, v245
v_pk_mul_f32 v[248:249], v[248:249], s[54:55]
v_pk_mul_f32 v[250:251], v[250:251], s[54:55]
v_cvt_pk_bf16_f32 v248, v248, v249
v_cvt_pk_bf16_f32 v250, v250, v251
v_accvgpr_write_b32 a76, v248
v_accvgpr_write_b32 a77, v250
v_lshlrev_b32 v248, 16, v246
v_and_b32 v249, s39, v246
v_lshlrev_b32 v250, 16, v247
v_and_b32 v251, s39, v247
v_pk_mul_f32 v[248:249], v[248:249], s[54:55]
v_pk_mul_f32 v[250:251], v[250:251], s[54:55]
v_cvt_pk_bf16_f32 v248, v248, v249
v_cvt_pk_bf16_f32 v250, v250, v251
v_accvgpr_write_b32 a78, v248
v_accvgpr_write_b32 a79, v250
v_mfma_f32_16x16x32_bf16 v[192:195], a[128:131], a[64:67], 0
v_add_f32 v219, v219, v200
v_add_f32 v219, v219, v201
v_mfma_f32_16x16x32_bf16 v[192:195], a[132:135], a[68:71], v[192:195]
v_exp_f32 v205, v205
v_mfma_f32_16x16x32_bf16 v[192:195], a[136:139], a[72:75], v[192:195]
v_cvt_pk_bf16_f32 v214, v204, v205
v_add_f32 v219, v219, v202
v_mfma_f32_16x16x32_bf16 v[192:195], a[140:143], a[76:79], v[192:195]
v_exp_f32 v206, v206
v_mfma_f32_16x16x32_bf16 v[196:199], a[144:147], a[64:67], 0
v_add_f32 v219, v219, v203
v_add_f32 v219, v219, v204
v_mfma_f32_16x16x32_bf16 v[196:199], a[148:151], a[68:71], v[196:199]
v_exp_f32 v207, v207
v_mfma_f32_16x16x32_bf16 v[196:199], a[152:155], a[72:75], v[196:199]
v_cvt_pk_bf16_f32 v215, v206, v207
v_add_f32 v219, v219, v205
v_mfma_f32_16x16x32_bf16 v[196:199], a[156:159], a[76:79], v[196:199]
v_exp_f32 v192, v192
v_mfma_f32_16x16x32_bf16 v[32:35], a[160:163], v[212:215], v[32:35]
v_add_f32 v219, v219, v206
v_add_f32 v219, v219, v207
v_mfma_f32_16x16x32_bf16 v[36:39], a[164:167], v[212:215], v[36:39]
v_exp_f32 v193, v193
v_mfma_f32_16x16x32_bf16 v[40:43], a[168:171], v[212:215], v[40:43]
v_cvt_pk_bf16_f32 v208, v192, v193
v_add_f32 v220, v220, v192
v_mfma_f32_16x16x32_bf16 v[44:47], a[172:175], v[212:215], v[44:47]
v_exp_f32 v194, v194
v_mfma_f32_16x16x32_bf16 v[48:51], a[176:179], v[212:215], v[48:51]
v_add_f32 v220, v220, v193
v_add_f32 v220, v220, v194
v_mfma_f32_16x16x32_bf16 v[52:55], a[180:183], v[212:215], v[52:55]
v_exp_f32 v195, v195
v_mfma_f32_16x16x32_bf16 v[56:59], a[184:187], v[212:215], v[56:59]
v_cvt_pk_bf16_f32 v209, v194, v195
v_add_f32 v220, v220, v195
v_mfma_f32_16x16x32_bf16 v[60:63], a[188:191], v[212:215], v[60:63]
v_exp_f32 v196, v196
s_waitcnt vmcnt(4)
ds_read_b128 v[232:235], v231 offset:4352
ds_read_b128 v[236:239], v231 offset:4416
ds_read_b128 v[240:243], v231 offset:4480
ds_read_b128 v[244:247], v231 offset:4544
s_add_u32 m0, s48, 13056
s_nop 0
buffer_load_dwordx4 v230, s[16:19], 0 offen offset:0 nt lds
s_add_u32 m0, s48, 13120
s_nop 0
buffer_load_dwordx4 v230, s[16:19], 0 offen offset:1024 nt lds
s_add_u32 m0, s48, 13184
s_nop 0
buffer_load_dwordx4 v230, s[16:19], 0 offen offset:2048 nt lds
s_add_u32 m0, s48, 13248
s_nop 0
buffer_load_dwordx4 v230, s[16:19], 0 offen offset:3072 nt lds
v_add_u32 v230, 4096, v230
s_waitcnt lgkmcnt(0)
v_lshlrev_b32 v248, 16, v232
v_and_b32 v249, s39, v232
v_lshlrev_b32 v250, 16, v233
v_and_b32 v251, s39, v233
v_pk_mul_f32 v[248:249], v[248:249], s[54:55]
v_pk_mul_f32 v[250:251], v[250:251], s[54:55]
v_cvt_pk_bf16_f32 v248, v248, v249
v_cvt_pk_bf16_f32 v250, v250, v251
v_accvgpr_write_b32 a80, v248
v_accvgpr_write_b32 a81, v250
v_lshlrev_b32 v248, 16, v234
v_and_b32 v249, s39, v234
v_lshlrev_b32 v250, 16, v235
v_and_b32 v251, s39, v235
v_pk_mul_f32 v[248:249], v[248:249], s[54:55]
v_pk_mul_f32 v[250:251], v[250:251], s[54:55]
v_cvt_pk_bf16_f32 v248, v248, v249
v_cvt_pk_bf16_f32 v250, v250, v251
v_accvgpr_write_b32 a82, v248
v_accvgpr_write_b32 a83, v250
v_lshlrev_b32 v248, 16, v236
v_and_b32 v249, s39, v236
v_lshlrev_b32 v250, 16, v237
v_and_b32 v251, s39, v237
v_pk_mul_f32 v[248:249], v[248:249], s[54:55]
v_pk_mul_f32 v[250:251], v[250:251], s[54:55]
v_cvt_pk_bf16_f32 v248, v248, v249
v_cvt_pk_bf16_f32 v250, v250, v251
v_accvgpr_write_b32 a84, v248
v_accvgpr_write_b32 a85, v250
v_lshlrev_b32 v248, 16, v238
v_and_b32 v249, s39, v238
v_lshlrev_b32 v250, 16, v239
v_and_b32 v251, s39, v239
v_pk_mul_f32 v[248:249], v[248:249], s[54:55]
v_pk_mul_f32 v[250:251], v[250:251], s[54:55]
v_cvt_pk_bf16_f32 v248, v248, v249
v_cvt_pk_bf16_f32 v250, v250, v251
v_accvgpr_write_b32 a86, v248
v_accvgpr_write_b32 a87, v250
v_lshlrev_b32 v248, 16, v240
v_and_b32 v249, s39, v240
v_lshlrev_b32 v250, 16, v241
v_and_b32 v251, s39, v241
v_pk_mul_f32 v[248:249], v[248:249], s[54:55]
v_pk_mul_f32 v[250:251], v[250:251], s[54:55]
v_cvt_pk_bf16_f32 v248, v248, v249
v_cvt_pk_bf16_f32 v250, v250, v251
v_accvgpr_write_b32 a88, v248
v_accvgpr_write_b32 a89, v250
v_lshlrev_b32 v248, 16, v242
v_and_b32 v249, s39, v242
v_lshlrev_b32 v250, 16, v243
v_and_b32 v251, s39, v243
v_pk_mul_f32 v[248:249], v[248:249], s[54:55]
v_pk_mul_f32 v[250:251], v[250:251], s[54:55]
v_cvt_pk_bf16_f32 v248, v248, v249
v_cvt_pk_bf16_f32 v250, v250, v251
v_accvgpr_write_b32 a90, v248
v_accvgpr_write_b32 a91, v250
v_lshlrev_b32 v248, 16, v244
v_and_b32 v249, s39, v244
v_lshlrev_b32 v250, 16, v245
v_and_b32 v251, s39, v245
v_pk_mul_f32 v[248:249], v[248:249], s[54:55]
v_pk_mul_f32 v[250:251], v[250:251], s[54:55]
v_cvt_pk_bf16_f32 v248, v248, v249
v_cvt_pk_bf16_f32 v250, v250, v251
v_accvgpr_write_b32 a92, v248
v_accvgpr_write_b32 a93, v250
v_lshlrev_b32 v248, 16, v246
v_and_b32 v249, s39, v246
v_lshlrev_b32 v250, 16, v247
v_and_b32 v251, s39, v247
v_pk_mul_f32 v[248:249], v[248:249], s[54:55]
v_pk_mul_f32 v[250:251], v[250:251], s[54:55]
v_cvt_pk_bf16_f32 v248, v248, v249
v_cvt_pk_bf16_f32 v250, v250, v251
v_accvgpr_write_b32 a94, v248
v_accvgpr_write_b32 a95, v250
v_mfma_f32_16x16x32_bf16 v[200:203], a[128:131], a[80:83], 0
ds_read_b128 a[128:131], v224 offset:17152
v_add_f32 v220, v220, v196
v_mfma_f32_16x16x32_bf16 v[200:203], a[132:135], a[84:87], v[200:203]
v_exp_f32 v197, v197
v_mfma_f32_16x16x32_bf16 v[200:203], a[136:139], a[88:91], v[200:203]
ds_read_b128 a[132:135], v224 offset:17216
v_cvt_pk_bf16_f32 v210, v196, v197
v_mfma_f32_16x16x32_bf16 v[200:203], a[140:143], a[92:95], v[200:203]
v_exp_f32 v198, v198
v_mfma_f32_16x16x32_bf16 v[204:207], a[144:147], a[80:83], 0
ds_read_b128 a[136:139], v224 offset:17280
v_add_f32 v220, v220, v197
v_mfma_f32_16x16x32_bf16 v[204:207], a[148:151], a[84:87], v[204:207]
v_exp_f32 v199, v199
v_mfma_f32_16x16x32_bf16 v[204:207], a[152:155], a[88:91], v[204:207]
ds_read_b128 a[140:143], v224 offset:17344
v_cvt_pk_bf16_f32 v211, v198, v199
v_mfma_f32_16x16x32_bf16 v[204:207], a[156:159], a[92:95], v[204:207]
v_exp_f32 v200, v200
v_mfma_f32_16x16x32_bf16 v[64:67], a[160:163], v[208:211], 0
ds_read_b128 a[144:147], v224 offset:21504
v_add_f32 v220, v220, v198
v_mfma_f32_16x16x32_bf16 v[68:71], a[164:167], v[208:211], 0
v_exp_f32 v201, v201
v_mfma_f32_16x16x32_bf16 v[72:75], a[168:171], v[208:211], 0
ds_read_b128 a[148:151], v224 offset:21568
v_cvt_pk_bf16_f32 v212, v200, v201
v_mfma_f32_16x16x32_bf16 v[76:79], a[172:175], v[208:211], 0
v_exp_f32 v202, v202
v_mfma_f32_16x16x32_bf16 v[80:83], a[176:179], v[208:211], 0
ds_read_b128 a[152:155], v224 offset:21632
v_add_f32 v220, v220, v199
v_mfma_f32_16x16x32_bf16 v[84:87], a[180:183], v[208:211], 0
s_waitcnt lgkmcnt(3)
v_exp_f32 v203, v203
v_mfma_f32_16x16x32_bf16 v[88:91], a[184:187], v[208:211], 0
ds_read_b128 a[156:159], v224 offset:21696
v_cvt_pk_bf16_f32 v213, v202, v203
v_mfma_f32_16x16x32_bf16 v[92:95], a[188:191], v[208:211], 0
v_exp_f32 v204, v204
v_mfma_f32_16x16x32_bf16 v[192:195], a[128:131], a[64:67], 0
v_add_f32 v221, v221, v200
v_add_f32 v221, v221, v201
v_mfma_f32_16x16x32_bf16 v[192:195], a[132:135], a[68:71], v[192:195]
v_exp_f32 v205, v205
v_mfma_f32_16x16x32_bf16 v[192:195], a[136:139], a[72:75], v[192:195]
v_cvt_pk_bf16_f32 v214, v204, v205
v_add_f32 v221, v221, v202
v_mfma_f32_16x16x32_bf16 v[192:195], a[140:143], a[76:79], v[192:195]
s_waitcnt lgkmcnt(1)
v_exp_f32 v206, v206
v_mfma_f32_16x16x32_bf16 v[196:199], a[144:147], a[64:67], 0
v_add_f32 v221, v221, v203
v_add_f32 v221, v221, v204
v_mfma_f32_16x16x32_bf16 v[196:199], a[148:151], a[68:71], v[196:199]
v_exp_f32 v207, v207
v_mfma_f32_16x16x32_bf16 v[196:199], a[152:155], a[72:75], v[196:199]
s_waitcnt lgkmcnt(0)
v_cvt_pk_bf16_f32 v215, v206, v207
v_add_f32 v221, v221, v205
v_mfma_f32_16x16x32_bf16 v[196:199], a[156:159], a[76:79], v[196:199]
v_exp_f32 v192, v192
v_mfma_f32_16x16x32_bf16 v[96:99], a[160:163], v[212:215], 0
ds_read_b64_tr_b16 a[160:161], v225 offset:17152
v_add_f32 v221, v221, v206
v_mfma_f32_16x16x32_bf16 v[100:103], a[164:167], v[212:215], 0
ds_read_b64_tr_b16 a[162:163], v225 offset:17664
v_exp_f32 v193, v193
v_mfma_f32_16x16x32_bf16 v[104:107], a[168:171], v[212:215], 0
ds_read_b64_tr_b16 a[164:165], v225 offset:17184
v_cvt_pk_bf16_f32 v208, v192, v193
v_mfma_f32_16x16x32_bf16 v[108:111], a[172:175], v[212:215], 0
ds_read_b64_tr_b16 a[166:167], v225 offset:17696
v_exp_f32 v194, v194
v_mfma_f32_16x16x32_bf16 v[112:115], a[176:179], v[212:215], 0
ds_read_b64_tr_b16 a[168:169], v225 offset:17216
v_add_f32 v221, v221, v207
v_mfma_f32_16x16x32_bf16 v[116:119], a[180:183], v[212:215], 0
ds_read_b64_tr_b16 a[170:171], v225 offset:17728
v_exp_f32 v195, v195
v_mfma_f32_16x16x32_bf16 v[120:123], a[184:187], v[212:215], 0
ds_read_b64_tr_b16 a[172:173], v225 offset:17248
v_cvt_pk_bf16_f32 v209, v194, v195
v_mfma_f32_16x16x32_bf16 v[124:127], a[188:191], v[212:215], 0
ds_read_b64_tr_b16 a[174:175], v225 offset:17760
v_exp_f32 v196, v196
v_mfma_f32_16x16x32_bf16 v[200:203], a[128:131], a[80:83], 0
ds_read_b64_tr_b16 a[176:177], v225 offset:17280
v_add_f32 v220, v220, v192
v_mfma_f32_16x16x32_bf16 v[200:203], a[132:135], a[84:87], v[200:203]
ds_read_b64_tr_b16 a[178:179], v225 offset:17792
v_exp_f32 v197, v197
v_mfma_f32_16x16x32_bf16 v[200:203], a[136:139], a[88:91], v[200:203]
ds_read_b64_tr_b16 a[180:181], v225 offset:17312
v_cvt_pk_bf16_f32 v210, v196, v197
v_mfma_f32_16x16x32_bf16 v[200:203], a[140:143], a[92:95], v[200:203]
ds_read_b64_tr_b16 a[182:183], v225 offset:17824
v_exp_f32 v198, v198
v_mfma_f32_16x16x32_bf16 v[204:207], a[144:147], a[80:83], 0
ds_read_b64_tr_b16 a[184:185], v225 offset:17344
v_add_f32 v220, v220, v193
v_mfma_f32_16x16x32_bf16 v[204:207], a[148:151], a[84:87], v[204:207]
ds_read_b64_tr_b16 a[186:187], v225 offset:17856
v_exp_f32 v199, v199
v_mfma_f32_16x16x32_bf16 v[204:207], a[152:155], a[88:91], v[204:207]
ds_read_b64_tr_b16 a[188:189], v225 offset:17376
v_cvt_pk_bf16_f32 v211, v198, v199
v_mfma_f32_16x16x32_bf16 v[204:207], a[156:159], a[92:95], v[204:207]
s_waitcnt lgkmcnt(7)
ds_read_b64_tr_b16 a[190:191], v225 offset:17888
v_exp_f32 v200, v200
v_mfma_f32_16x16x32_bf16 v[64:67], a[160:163], v[208:211], v[64:67]
v_add_f32 v220, v220, v194
v_add_f32 v220, v220, v195
v_mfma_f32_16x16x32_bf16 v[68:71], a[164:167], v[208:211], v[68:71]
v_exp_f32 v201, v201
v_mfma_f32_16x16x32_bf16 v[72:75], a[168:171], v[208:211], v[72:75]
v_cvt_pk_bf16_f32 v212, v200, v201
v_add_f32 v220, v220, v196
v_mfma_f32_16x16x32_bf16 v[76:79], a[172:175], v[208:211], v[76:79]
s_waitcnt lgkmcnt(4)
v_exp_f32 v202, v202
v_mfma_f32_16x16x32_bf16 v[80:83], a[176:179], v[208:211], v[80:83]
v_add_f32 v220, v220, v197
v_add_f32 v220, v220, v198
v_mfma_f32_16x16x32_bf16 v[84:87], a[180:183], v[208:211], v[84:87]
s_waitcnt lgkmcnt(0)
v_exp_f32 v203, v203
v_mfma_f32_16x16x32_bf16 v[88:91], a[184:187], v[208:211], v[88:91]
v_cvt_pk_bf16_f32 v213, v202, v203
v_add_f32 v220, v220, v199
v_mfma_f32_16x16x32_bf16 v[92:95], a[188:191], v[208:211], v[92:95]
v_exp_f32 v204, v204
s_waitcnt vmcnt(4)
ds_read_b128 v[232:235], v231 offset:8704
ds_read_b128 v[236:239], v231 offset:8768
ds_read_b128 v[240:243], v231 offset:8832
ds_read_b128 v[244:247], v231 offset:8896
s_mov_b32 m0, s34
s_nop 0
buffer_load_dwordx4 v226, s[20:23], s35 offen nt lds
s_add_u32 m0, s34, 4352
s_nop 0
buffer_load_dwordx4 v227, s[20:23], s35 offen nt lds
s_add_u32 m0, s34, s44
s_nop 0
buffer_load_dwordx4 v228, s[24:27], s35 offen nt lds
s_add_u32 m0, s34, s45
s_nop 0
buffer_load_dwordx4 v229, s[24:27], s35 offen nt lds
s_add_u32 s35, s35, 8192
s_add_u32 s34, s34, 17152
s_waitcnt lgkmcnt(0)
v_lshlrev_b32 v248, 16, v232
v_and_b32 v249, s39, v232
v_lshlrev_b32 v250, 16, v233
v_and_b32 v251, s39, v233
v_pk_mul_f32 v[248:249], v[248:249], s[54:55]
v_pk_mul_f32 v[250:251], v[250:251], s[54:55]
v_cvt_pk_bf16_f32 v248, v248, v249
v_cvt_pk_bf16_f32 v250, v250, v251
v_accvgpr_write_b32 a96, v248
v_accvgpr_write_b32 a97, v250
v_lshlrev_b32 v248, 16, v234
v_and_b32 v249, s39, v234
v_lshlrev_b32 v250, 16, v235
v_and_b32 v251, s39, v235
v_pk_mul_f32 v[248:249], v[248:249], s[54:55]
v_pk_mul_f32 v[250:251], v[250:251], s[54:55]
v_cvt_pk_bf16_f32 v248, v248, v249
v_cvt_pk_bf16_f32 v250, v250, v251
v_accvgpr_write_b32 a98, v248
v_accvgpr_write_b32 a99, v250
v_lshlrev_b32 v248, 16, v236
v_and_b32 v249, s39, v236
v_lshlrev_b32 v250, 16, v237
v_and_b32 v251, s39, v237
v_pk_mul_f32 v[248:249], v[248:249], s[54:55]
v_pk_mul_f32 v[250:251], v[250:251], s[54:55]
v_cvt_pk_bf16_f32 v248, v248, v249
v_cvt_pk_bf16_f32 v250, v250, v251
v_accvgpr_write_b32 a100, v248
v_accvgpr_write_b32 a101, v250
v_lshlrev_b32 v248, 16, v238
v_and_b32 v249, s39, v238
v_lshlrev_b32 v250, 16, v239
v_and_b32 v251, s39, v239
v_pk_mul_f32 v[248:249], v[248:249], s[54:55]
v_pk_mul_f32 v[250:251], v[250:251], s[54:55]
v_cvt_pk_bf16_f32 v248, v248, v249
v_cvt_pk_bf16_f32 v250, v250, v251
v_accvgpr_write_b32 a102, v248
v_accvgpr_write_b32 a103, v250
v_lshlrev_b32 v248, 16, v240
v_and_b32 v249, s39, v240
v_lshlrev_b32 v250, 16, v241
v_and_b32 v251, s39, v241
v_pk_mul_f32 v[248:249], v[248:249], s[54:55]
v_pk_mul_f32 v[250:251], v[250:251], s[54:55]
v_cvt_pk_bf16_f32 v248, v248, v249
v_cvt_pk_bf16_f32 v250, v250, v251
v_accvgpr_write_b32 a104, v248
v_accvgpr_write_b32 a105, v250
v_lshlrev_b32 v248, 16, v242
v_and_b32 v249, s39, v242
v_lshlrev_b32 v250, 16, v243
v_and_b32 v251, s39, v243
v_pk_mul_f32 v[248:249], v[248:249], s[54:55]
v_pk_mul_f32 v[250:251], v[250:251], s[54:55]
v_cvt_pk_bf16_f32 v248, v248, v249
v_cvt_pk_bf16_f32 v250, v250, v251
v_accvgpr_write_b32 a106, v248
v_accvgpr_write_b32 a107, v250
v_lshlrev_b32 v248, 16, v244
v_and_b32 v249, s39, v244
v_lshlrev_b32 v250, 16, v245
v_and_b32 v251, s39, v245
v_pk_mul_f32 v[248:249], v[248:249], s[54:55]
v_pk_mul_f32 v[250:251], v[250:251], s[54:55]
v_cvt_pk_bf16_f32 v248, v248, v249
v_cvt_pk_bf16_f32 v250, v250, v251
v_accvgpr_write_b32 a108, v248
v_accvgpr_write_b32 a109, v250
v_lshlrev_b32 v248, 16, v246
v_and_b32 v249, s39, v246
v_lshlrev_b32 v250, 16, v247
v_and_b32 v251, s39, v247
v_pk_mul_f32 v[248:249], v[248:249], s[54:55]
v_pk_mul_f32 v[250:251], v[250:251], s[54:55]
v_cvt_pk_bf16_f32 v248, v248, v249
v_cvt_pk_bf16_f32 v250, v250, v251
v_accvgpr_write_b32 a110, v248
v_accvgpr_write_b32 a111, v250
v_mfma_f32_16x16x32_bf16 v[192:195], a[128:131], a[96:99], 0
v_add_f32 v221, v221, v200
v_add_f32 v221, v221, v201
v_mfma_f32_16x16x32_bf16 v[192:195], a[132:135], a[100:103], v[192:195]
v_exp_f32 v205, v205
v_mfma_f32_16x16x32_bf16 v[192:195], a[136:139], a[104:107], v[192:195]
v_cvt_pk_bf16_f32 v214, v204, v205
v_add_f32 v221, v221, v202
v_mfma_f32_16x16x32_bf16 v[192:195], a[140:143], a[108:111], v[192:195]
v_exp_f32 v206, v206
v_mfma_f32_16x16x32_bf16 v[196:199], a[144:147], a[96:99], 0
v_add_f32 v221, v221, v203
v_add_f32 v221, v221, v204
v_mfma_f32_16x16x32_bf16 v[196:199], a[148:151], a[100:103], v[196:199]
v_exp_f32 v207, v207
v_mfma_f32_16x16x32_bf16 v[196:199], a[152:155], a[104:107], v[196:199]
v_cvt_pk_bf16_f32 v215, v206, v207
v_add_f32 v221, v221, v205
v_mfma_f32_16x16x32_bf16 v[196:199], a[156:159], a[108:111], v[196:199]
v_exp_f32 v192, v192
v_mfma_f32_16x16x32_bf16 v[96:99], a[160:163], v[212:215], v[96:99]
v_add_f32 v221, v221, v206
v_add_f32 v221, v221, v207
v_mfma_f32_16x16x32_bf16 v[100:103], a[164:167], v[212:215], v[100:103]
v_exp_f32 v193, v193
v_mfma_f32_16x16x32_bf16 v[104:107], a[168:171], v[212:215], v[104:107]
v_cvt_pk_bf16_f32 v208, v192, v193
v_add_f32 v222, v222, v192
v_mfma_f32_16x16x32_bf16 v[108:111], a[172:175], v[212:215], v[108:111]
v_exp_f32 v194, v194
v_mfma_f32_16x16x32_bf16 v[112:115], a[176:179], v[212:215], v[112:115]
v_add_f32 v222, v222, v193
v_add_f32 v222, v222, v194
v_mfma_f32_16x16x32_bf16 v[116:119], a[180:183], v[212:215], v[116:119]
v_exp_f32 v195, v195
v_mfma_f32_16x16x32_bf16 v[120:123], a[184:187], v[212:215], v[120:123]
v_cvt_pk_bf16_f32 v209, v194, v195
v_add_f32 v222, v222, v195
v_mfma_f32_16x16x32_bf16 v[124:127], a[188:191], v[212:215], v[124:127]
v_exp_f32 v196, v196
s_waitcnt vmcnt(4)
ds_read_b128 v[232:235], v231 offset:13056
ds_read_b128 v[236:239], v231 offset:13120
ds_read_b128 v[240:243], v231 offset:13184
ds_read_b128 v[244:247], v231 offset:13248
s_mov_b32 m0, s34
s_nop 0
buffer_load_dwordx4 v226, s[20:23], s35 offen nt lds
s_add_u32 m0, s34, 4352
s_nop 0
buffer_load_dwordx4 v227, s[20:23], s35 offen nt lds
s_add_u32 m0, s34, s44
s_nop 0
buffer_load_dwordx4 v228, s[24:27], s35 offen nt lds
s_add_u32 m0, s34, s45
s_nop 0
buffer_load_dwordx4 v229, s[24:27], s35 offen nt lds
s_add_u32 s35, s35, 8192
s_add_u32 s34, s34, 17152
s_waitcnt lgkmcnt(0)
v_lshlrev_b32 v248, 16, v232
v_and_b32 v249, s39, v232
v_lshlrev_b32 v250, 16, v233
v_and_b32 v251, s39, v233
v_pk_mul_f32 v[248:249], v[248:249], s[54:55]
v_pk_mul_f32 v[250:251], v[250:251], s[54:55]
v_cvt_pk_bf16_f32 v248, v248, v249
v_cvt_pk_bf16_f32 v250, v250, v251
v_accvgpr_write_b32 a112, v248
v_accvgpr_write_b32 a113, v250
v_lshlrev_b32 v248, 16, v234
v_and_b32 v249, s39, v234
v_lshlrev_b32 v250, 16, v235
v_and_b32 v251, s39, v235
v_pk_mul_f32 v[248:249], v[248:249], s[54:55]
v_pk_mul_f32 v[250:251], v[250:251], s[54:55]
v_cvt_pk_bf16_f32 v248, v248, v249
v_cvt_pk_bf16_f32 v250, v250, v251
v_accvgpr_write_b32 a114, v248
v_accvgpr_write_b32 a115, v250
v_lshlrev_b32 v248, 16, v236
v_and_b32 v249, s39, v236
v_lshlrev_b32 v250, 16, v237
v_and_b32 v251, s39, v237
v_pk_mul_f32 v[248:249], v[248:249], s[54:55]
v_pk_mul_f32 v[250:251], v[250:251], s[54:55]
v_cvt_pk_bf16_f32 v248, v248, v249
v_cvt_pk_bf16_f32 v250, v250, v251
v_accvgpr_write_b32 a116, v248
v_accvgpr_write_b32 a117, v250
v_lshlrev_b32 v248, 16, v238
v_and_b32 v249, s39, v238
v_lshlrev_b32 v250, 16, v239
v_and_b32 v251, s39, v239
v_pk_mul_f32 v[248:249], v[248:249], s[54:55]
v_pk_mul_f32 v[250:251], v[250:251], s[54:55]
v_cvt_pk_bf16_f32 v248, v248, v249
v_cvt_pk_bf16_f32 v250, v250, v251
v_accvgpr_write_b32 a118, v248
v_accvgpr_write_b32 a119, v250
v_lshlrev_b32 v248, 16, v240
v_and_b32 v249, s39, v240
v_lshlrev_b32 v250, 16, v241
v_and_b32 v251, s39, v241
v_pk_mul_f32 v[248:249], v[248:249], s[54:55]
v_pk_mul_f32 v[250:251], v[250:251], s[54:55]
v_cvt_pk_bf16_f32 v248, v248, v249
v_cvt_pk_bf16_f32 v250, v250, v251
v_accvgpr_write_b32 a120, v248
v_accvgpr_write_b32 a121, v250
v_lshlrev_b32 v248, 16, v242
v_and_b32 v249, s39, v242
v_lshlrev_b32 v250, 16, v243
v_and_b32 v251, s39, v243
v_pk_mul_f32 v[248:249], v[248:249], s[54:55]
v_pk_mul_f32 v[250:251], v[250:251], s[54:55]
v_cvt_pk_bf16_f32 v248, v248, v249
v_cvt_pk_bf16_f32 v250, v250, v251
v_accvgpr_write_b32 a122, v248
v_accvgpr_write_b32 a123, v250
v_lshlrev_b32 v248, 16, v244
v_and_b32 v249, s39, v244
v_lshlrev_b32 v250, 16, v245
v_and_b32 v251, s39, v245
v_pk_mul_f32 v[248:249], v[248:249], s[54:55]
v_pk_mul_f32 v[250:251], v[250:251], s[54:55]
v_cvt_pk_bf16_f32 v248, v248, v249
v_cvt_pk_bf16_f32 v250, v250, v251
v_accvgpr_write_b32 a124, v248
v_accvgpr_write_b32 a125, v250
v_lshlrev_b32 v248, 16, v246
v_and_b32 v249, s39, v246
v_lshlrev_b32 v250, 16, v247
v_and_b32 v251, s39, v247
v_pk_mul_f32 v[248:249], v[248:249], s[54:55]
v_pk_mul_f32 v[250:251], v[250:251], s[54:55]
v_cvt_pk_bf16_f32 v248, v248, v249
v_cvt_pk_bf16_f32 v250, v250, v251
v_accvgpr_write_b32 a126, v248
v_accvgpr_write_b32 a127, v250
v_mfma_f32_16x16x32_bf16 v[200:203], a[128:131], a[112:115], 0
ds_read_b128 a[128:131], v224 offset:0
v_add_f32 v222, v222, v196
v_mfma_f32_16x16x32_bf16 v[200:203], a[132:135], a[116:119], v[200:203]
v_exp_f32 v197, v197
v_mfma_f32_16x16x32_bf16 v[200:203], a[136:139], a[120:123], v[200:203]
ds_read_b128 a[132:135], v224 offset:64
v_cvt_pk_bf16_f32 v210, v196, v197
v_mfma_f32_16x16x32_bf16 v[200:203], a[140:143], a[124:127], v[200:203]
v_exp_f32 v198, v198
v_mfma_f32_16x16x32_bf16 v[204:207], a[144:147], a[112:115], 0
ds_read_b128 a[136:139], v224 offset:128
v_add_f32 v222, v222, v197
v_mfma_f32_16x16x32_bf16 v[204:207], a[148:151], a[116:119], v[204:207]
v_exp_f32 v199, v199
v_mfma_f32_16x16x32_bf16 v[204:207], a[152:155], a[120:123], v[204:207]
ds_read_b128 a[140:143], v224 offset:192
v_cvt_pk_bf16_f32 v211, v198, v199
v_mfma_f32_16x16x32_bf16 v[204:207], a[156:159], a[124:127], v[204:207]
v_exp_f32 v200, v200
v_mfma_f32_16x16x32_bf16 v[128:131], a[160:163], v[208:211], 0
ds_read_b128 a[144:147], v224 offset:4352
v_add_f32 v222, v222, v198
v_mfma_f32_16x16x32_bf16 v[132:135], a[164:167], v[208:211], 0
v_exp_f32 v201, v201
v_mfma_f32_16x16x32_bf16 v[136:139], a[168:171], v[208:211], 0
ds_read_b128 a[148:151], v224 offset:4416
v_cvt_pk_bf16_f32 v212, v200, v201
v_mfma_f32_16x16x32_bf16 v[140:143], a[172:175], v[208:211], 0
v_exp_f32 v202, v202
v_mfma_f32_16x16x32_bf16 v[144:147], a[176:179], v[208:211], 0
ds_read_b128 a[152:155], v224 offset:4480
v_add_f32 v222, v222, v199
v_mfma_f32_16x16x32_bf16 v[148:151], a[180:183], v[208:211], 0
s_waitcnt lgkmcnt(3)
v_exp_f32 v203, v203
v_mfma_f32_16x16x32_bf16 v[152:155], a[184:187], v[208:211], 0
ds_read_b128 a[156:159], v224 offset:4544
v_cvt_pk_bf16_f32 v213, v202, v203
v_mfma_f32_16x16x32_bf16 v[156:159], a[188:191], v[208:211], 0
v_exp_f32 v204, v204
v_mfma_f32_16x16x32_bf16 v[192:195], a[128:131], a[96:99], 0
v_add_f32 v223, v223, v200
v_add_f32 v223, v223, v201
v_mfma_f32_16x16x32_bf16 v[192:195], a[132:135], a[100:103], v[192:195]
v_exp_f32 v205, v205
v_mfma_f32_16x16x32_bf16 v[192:195], a[136:139], a[104:107], v[192:195]
v_cvt_pk_bf16_f32 v214, v204, v205
v_add_f32 v223, v223, v202
v_mfma_f32_16x16x32_bf16 v[192:195], a[140:143], a[108:111], v[192:195]
s_waitcnt lgkmcnt(1)
v_exp_f32 v206, v206
v_mfma_f32_16x16x32_bf16 v[196:199], a[144:147], a[96:99], 0
v_add_f32 v223, v223, v203
v_add_f32 v223, v223, v204
v_mfma_f32_16x16x32_bf16 v[196:199], a[148:151], a[100:103], v[196:199]
v_exp_f32 v207, v207
v_mfma_f32_16x16x32_bf16 v[196:199], a[152:155], a[104:107], v[196:199]
s_waitcnt lgkmcnt(0)
v_cvt_pk_bf16_f32 v215, v206, v207
v_add_f32 v223, v223, v205
v_mfma_f32_16x16x32_bf16 v[196:199], a[156:159], a[108:111], v[196:199]
v_exp_f32 v192, v192
v_mfma_f32_16x16x32_bf16 v[160:163], a[160:163], v[212:215], 0
ds_read_b64_tr_b16 a[160:161], v225 offset:0
v_add_f32 v223, v223, v206
v_mfma_f32_16x16x32_bf16 v[164:167], a[164:167], v[212:215], 0
ds_read_b64_tr_b16 a[162:163], v225 offset:512
v_exp_f32 v193, v193
v_mfma_f32_16x16x32_bf16 v[168:171], a[168:171], v[212:215], 0
ds_read_b64_tr_b16 a[164:165], v225 offset:32
v_cvt_pk_bf16_f32 v208, v192, v193
v_mfma_f32_16x16x32_bf16 v[172:175], a[172:175], v[212:215], 0
ds_read_b64_tr_b16 a[166:167], v225 offset:544
v_exp_f32 v194, v194
v_mfma_f32_16x16x32_bf16 v[176:179], a[176:179], v[212:215], 0
ds_read_b64_tr_b16 a[168:169], v225 offset:64
v_add_f32 v223, v223, v207
v_add_f32 v222, v222, v194
v_mfma_f32_16x16x32_bf16 v[180:183], a[180:183], v[212:215], 0
ds_read_b64_tr_b16 a[170:171], v225 offset:576
v_exp_f32 v195, v195
v_mfma_f32_16x16x32_bf16 v[184:187], a[184:187], v[212:215], 0
ds_read_b64_tr_b16 a[172:173], v225 offset:96
v_cvt_pk_bf16_f32 v209, v194, v195
v_add_f32 v222, v222, v195
v_mfma_f32_16x16x32_bf16 v[188:191], a[188:191], v[212:215], 0
ds_read_b64_tr_b16 a[174:175], v225 offset:608
v_exp_f32 v196, v196
s_waitcnt vmcnt(6)
s_barrier
v_mfma_f32_16x16x32_bf16 v[200:203], a[128:131], a[112:115], 0
ds_read_b64_tr_b16 a[176:177], v225 offset:128
ds_read_b128 a[128:131], v224 offset:34304
v_add_f32 v222, v222, v196
v_mfma_f32_16x16x32_bf16 v[200:203], a[132:135], a[116:119], v[200:203]
ds_read_b64_tr_b16 a[178:179], v225 offset:640
v_exp_f32 v197, v197
v_mfma_f32_16x16x32_bf16 v[200:203], a[136:139], a[120:123], v[200:203]
ds_read_b64_tr_b16 a[180:181], v225 offset:160
ds_read_b128 a[132:135], v224 offset:34368
v_cvt_pk_bf16_f32 v210, v196, v197
v_mfma_f32_16x16x32_bf16 v[200:203], a[140:143], a[124:127], v[200:203]
ds_read_b64_tr_b16 a[182:183], v225 offset:672
v_exp_f32 v198, v198
v_mfma_f32_16x16x32_bf16 v[204:207], a[144:147], a[112:115], 0
ds_read_b64_tr_b16 a[184:185], v225 offset:192
ds_read_b128 a[136:139], v224 offset:34432
v_add_f32 v222, v222, v197
v_mfma_f32_16x16x32_bf16 v[204:207], a[148:151], a[116:119], v[204:207]
ds_read_b64_tr_b16 a[186:187], v225 offset:704
v_exp_f32 v199, v199
v_mfma_f32_16x16x32_bf16 v[204:207], a[152:155], a[120:123], v[204:207]
ds_read_b64_tr_b16 a[188:189], v225 offset:224
ds_read_b128 a[140:143], v224 offset:34496
v_cvt_pk_bf16_f32 v211, v198, v199
v_mfma_f32_16x16x32_bf16 v[204:207], a[156:159], a[124:127], v[204:207]
s_waitcnt lgkmcnt(11)
ds_read_b64_tr_b16 a[190:191], v225 offset:736
v_exp_f32 v200, v200
v_mfma_f32_16x16x32_bf16 v[128:131], a[160:163], v[208:211], v[128:131]
ds_read_b128 a[144:147], v224 offset:38656
v_add_f32 v222, v222, v192
v_add_f32 v222, v222, v198
v_mfma_f32_16x16x32_bf16 v[132:135], a[164:167], v[208:211], v[132:135]
v_exp_f32 v201, v201
v_add_f32 v222, v222, v199
v_mfma_f32_16x16x32_bf16 v[136:139], a[168:171], v[208:211], v[136:139]
ds_read_b128 a[148:151], v224 offset:38720
v_cvt_pk_bf16_f32 v212, v200, v201
v_add_f32 v223, v223, v200
v_mfma_f32_16x16x32_bf16 v[140:143], a[172:175], v[208:211], v[140:143]
s_waitcnt lgkmcnt(8)
v_exp_f32 v202, v202
v_mfma_f32_16x16x32_bf16 v[144:147], a[176:179], v[208:211], v[144:147]
ds_read_b128 a[152:155], v224 offset:38784
v_add_f32 v222, v222, v193
v_mfma_f32_16x16x32_bf16 v[148:151], a[180:183], v[208:211], v[148:151]
s_waitcnt lgkmcnt(3)
v_exp_f32 v203, v203
v_mfma_f32_16x16x32_bf16 v[152:155], a[184:187], v[208:211], v[152:155]
s_waitcnt lgkmcnt(4)
ds_read_b128 a[156:159], v224 offset:38848
v_cvt_pk_bf16_f32 v213, v202, v203
v_mfma_f32_16x16x32_bf16 v[156:159], a[188:191], v[208:211], v[156:159]
v_add_u32 v224, 34304, v224
v_add_u32 v225, 34304, v225
s_mov_b32 s34, s46
s_mov_b32 s37, 3
s_mov_b32 s36, 17152
s_waitcnt vmcnt(4)
s_waitcnt lgkmcnt(4)
s_barrier
s_mov_b32 m0, s34
s_nop 0
buffer_load_dwordx4 v226, s[20:23], s35 offen nt lds
s_add_u32 m0, s34, 4352
s_nop 0
buffer_load_dwordx4 v227, s[20:23], s35 offen nt lds
s_add_u32 m0, s34, s44
s_nop 0
buffer_load_dwordx4 v228, s[24:27], s35 offen nt lds
s_add_u32 m0, s34, s45
s_nop 0
buffer_load_dwordx4 v229, s[24:27], s35 offen nt lds
s_add_u32 s35, s35, 8192
s_add_u32 s34, s34, 17152
.p2align 6
L_loop:
v_exp_f32 v204, v204
v_mfma_f32_16x16x32_bf16 v[192:195], a[128:131], a[0:3], 0
v_add_f32 v223, v223, v201
v_add_f32 v223, v223, v202
v_mfma_f32_16x16x32_bf16 v[192:195], a[132:135], a[4:7], v[192:195]
v_exp_f32 v205, v205
v_mfma_f32_16x16x32_bf16 v[192:195], a[136:139], a[8:11], v[192:195]
v_cvt_pk_bf16_f32 v214, v204, v205
v_add_f32 v223, v223, v203
v_mfma_f32_16x16x32_bf16 v[192:195], a[140:143], a[12:15], v[192:195]
s_waitcnt lgkmcnt(1)
v_exp_f32 v206, v206
v_mfma_f32_16x16x32_bf16 v[196:199], a[144:147], a[0:3], 0
v_add_f32 v223, v223, v204
v_add_f32 v223, v223, v205
v_mfma_f32_16x16x32_bf16 v[196:199], a[148:151], a[4:7], v[196:199]
v_exp_f32 v207, v207
v_mfma_f32_16x16x32_bf16 v[196:199], a[152:155], a[8:11], v[196:199]
s_waitcnt lgkmcnt(0)
v_cvt_pk_bf16_f32 v215, v206, v207
v_add_f32 v223, v223, v206
v_mfma_f32_16x16x32_bf16 v[196:199], a[156:159], a[12:15], v[196:199]
v_exp_f32 v192, v192
v_mfma_f32_16x16x32_bf16 v[160:163], a[160:163], v[212:215], v[160:163]
ds_read_b64_tr_b16 a[160:161], v225 offset:0
v_add_f32 v223, v223, v207
v_mfma_f32_16x16x32_bf16 v[164:167], a[164:167], v[212:215], v[164:167]
ds_read_b64_tr_b16 a[162:163], v225 offset:512
v_exp_f32 v193, v193
v_mfma_f32_16x16x32_bf16 v[168:171], a[168:171], v[212:215], v[168:171]
ds_read_b64_tr_b16 a[164:165], v225 offset:32
v_cvt_pk_bf16_f32 v208, v192, v193
v_mfma_f32_16x16x32_bf16 v[172:175], a[172:175], v[212:215], v[172:175]
ds_read_b64_tr_b16 a[166:167], v225 offset:544
v_exp_f32 v194, v194
v_mfma_f32_16x16x32_bf16 v[176:179], a[176:179], v[212:215], v[176:179]
ds_read_b64_tr_b16 a[168:169], v225 offset:64
v_add_f32 v216, v216, v192
v_mfma_f32_16x16x32_bf16 v[180:183], a[180:183], v[212:215], v[180:183]
ds_read_b64_tr_b16 a[170:171], v225 offset:576
v_exp_f32 v195, v195
v_mfma_f32_16x16x32_bf16 v[184:187], a[184:187], v[212:215], v[184:187]
ds_read_b64_tr_b16 a[172:173], v225 offset:96
v_cvt_pk_bf16_f32 v209, v194, v195
v_mfma_f32_16x16x32_bf16 v[188:191], a[188:191], v[212:215], v[188:191]
v_exp_f32 v196, v196
v_mfma_f32_16x16x32_bf16 v[200:203], a[128:131], a[16:19], 0
ds_read_b64_tr_b16 a[174:175], v225 offset:608
v_add_f32 v216, v216, v193
v_mfma_f32_16x16x32_bf16 v[200:203], a[132:135], a[20:23], v[200:203]
ds_read_b64_tr_b16 a[176:177], v225 offset:128
v_exp_f32 v197, v197
v_mfma_f32_16x16x32_bf16 v[200:203], a[136:139], a[24:27], v[200:203]
ds_read_b64_tr_b16 a[178:179], v225 offset:640
v_cvt_pk_bf16_f32 v210, v196, v197
v_mfma_f32_16x16x32_bf16 v[200:203], a[140:143], a[28:31], v[200:203]
ds_read_b64_tr_b16 a[180:181], v225 offset:160
v_exp_f32 v198, v198
v_mfma_f32_16x16x32_bf16 v[204:207], a[144:147], a[16:19], 0
ds_read_b64_tr_b16 a[182:183], v225 offset:672
v_add_f32 v216, v216, v194
v_mfma_f32_16x16x32_bf16 v[204:207], a[148:151], a[20:23], v[204:207]
v_exp_f32 v199, v199
v_mfma_f32_16x16x32_bf16 v[204:207], a[152:155], a[24:27], v[204:207]
ds_read_b64_tr_b16 a[184:185], v225 offset:192
v_cvt_pk_bf16_f32 v211, v198, v199
v_mfma_f32_16x16x32_bf16 v[204:207], a[156:159], a[28:31], v[204:207]
s_waitcnt lgkmcnt(7)
ds_read_b64_tr_b16 a[186:187], v225 offset:704
v_exp_f32 v200, v200
v_mfma_f32_16x16x32_bf16 a[192:195], a[160:163], v[208:211], a[192:195]
ds_read_b64_tr_b16 a[188:189], v225 offset:224
v_add_u32 v224, s36, v224
v_mfma_f32_16x16x32_bf16 a[196:199], a[164:167], v[208:211], a[196:199]
v_exp_f32 v201, v201
v_mfma_f32_16x16x32_bf16 a[200:203], a[168:171], v[208:211], a[200:203]
s_waitcnt lgkmcnt(5)
ds_read_b64_tr_b16 a[190:191], v225 offset:736
v_cvt_pk_bf16_f32 v212, v200, v201
v_mfma_f32_16x16x32_bf16 a[204:207], a[172:175], v[208:211], a[204:207]
v_exp_f32 v202, v202
v_mfma_f32_16x16x32_bf16 a[208:211], a[176:179], v[208:211], a[208:211]
s_waitcnt lgkmcnt(4)
v_add_u32 v225, s36, v225
v_add_f32 v216, v216, v195
v_mfma_f32_16x16x32_bf16 a[212:215], a[180:183], v[208:211], a[212:215]
s_waitcnt lgkmcnt(2)
v_exp_f32 v203, v203
v_mfma_f32_16x16x32_bf16 a[216:219], a[184:187], v[208:211], a[216:219]
s_waitcnt lgkmcnt(0)
v_cvt_pk_bf16_f32 v213, v202, v203
v_add_f32 v216, v216, v196
v_mfma_f32_16x16x32_bf16 a[220:223], a[188:191], v[208:211], a[220:223]
v_exp_f32 v204, v204
v_mfma_f32_16x16x32_bf16 v[192:195], a[128:131], a[32:35], 0
v_add_f32 v216, v216, v197
v_add_f32 v216, v216, v198
v_mfma_f32_16x16x32_bf16 v[192:195], a[132:135], a[36:39], v[192:195]
v_exp_f32 v205, v205
v_mfma_f32_16x16x32_bf16 v[192:195], a[136:139], a[40:43], v[192:195]
v_cvt_pk_bf16_f32 v214, v204, v205
v_add_f32 v216, v216, v199
v_mfma_f32_16x16x32_bf16 v[192:195], a[140:143], a[44:47], v[192:195]
s_mov_b32 m0, s34
v_exp_f32 v206, v206
v_mfma_f32_16x16x32_bf16 v[196:199], a[144:147], a[32:35], 0
buffer_load_dwordx4 v226, s[20:23], s35 offen nt lds
v_mfma_f32_16x16x32_bf16 v[196:199], a[148:151], a[36:39], v[196:199]
v_exp_f32 v207, v207
v_mfma_f32_16x16x32_bf16 v[196:199], a[152:155], a[40:43], v[196:199]
v_cvt_pk_bf16_f32 v215, v206, v207
v_add_f32 v217, v217, v200
v_mfma_f32_16x16x32_bf16 v[196:199], a[156:159], a[44:47], v[196:199]
v_exp_f32 v192, v192
v_mfma_f32_16x16x32_bf16 a[224:227], a[160:163], v[212:215], a[224:227]
v_add_f32 v217, v217, v201
v_add_f32 v217, v217, v202
v_mfma_f32_16x16x32_bf16 a[228:231], a[164:167], v[212:215], a[228:231]
v_exp_f32 v193, v193
v_mfma_f32_16x16x32_bf16 a[232:235], a[168:171], v[212:215], a[232:235]
v_cvt_pk_bf16_f32 v208, v192, v193
v_add_f32 v217, v217, v203
v_mfma_f32_16x16x32_bf16 a[236:239], a[172:175], v[212:215], a[236:239]
s_add_u32 m0, s34, 4352
v_exp_f32 v194, v194
v_mfma_f32_16x16x32_bf16 a[240:243], a[176:179], v[212:215], a[240:243]
buffer_load_dwordx4 v227, s[20:23], s35 offen nt lds
v_mfma_f32_16x16x32_bf16 a[244:247], a[180:183], v[212:215], a[244:247]
v_exp_f32 v195, v195
v_mfma_f32_16x16x32_bf16 a[248:251], a[184:187], v[212:215], a[248:251]
v_cvt_pk_bf16_f32 v209, v194, v195
v_add_f32 v217, v217, v204
v_mfma_f32_16x16x32_bf16 a[252:255], a[188:191], v[212:215], a[252:255]
v_exp_f32 v196, v196
v_mfma_f32_16x16x32_bf16 v[200:203], a[128:131], a[48:51], 0
v_add_f32 v217, v217, v205
v_add_f32 v217, v217, v206
v_mfma_f32_16x16x32_bf16 v[200:203], a[132:135], a[52:55], v[200:203]
v_exp_f32 v197, v197
v_mfma_f32_16x16x32_bf16 v[200:203], a[136:139], a[56:59], v[200:203]
v_cvt_pk_bf16_f32 v210, v196, v197
v_add_f32 v217, v217, v207
v_mfma_f32_16x16x32_bf16 v[200:203], a[140:143], a[60:63], v[200:203]
s_add_u32 m0, s34, s44
v_exp_f32 v198, v198
v_mfma_f32_16x16x32_bf16 v[204:207], a[144:147], a[48:51], 0
buffer_load_dwordx4 v228, s[24:27], s35 offen nt lds
v_mfma_f32_16x16x32_bf16 v[204:207], a[148:151], a[52:55], v[204:207]
v_exp_f32 v199, v199
v_mfma_f32_16x16x32_bf16 v[204:207], a[152:155], a[56:59], v[204:207]
v_cvt_pk_bf16_f32 v211, v198, v199
v_add_f32 v218, v218, v192
v_mfma_f32_16x16x32_bf16 v[204:207], a[156:159], a[60:63], v[204:207]
v_exp_f32 v200, v200
v_mfma_f32_16x16x32_bf16 v[0:3], a[160:163], v[208:211], v[0:3]
v_add_f32 v218, v218, v193
v_add_f32 v218, v218, v194
v_mfma_f32_16x16x32_bf16 v[4:7], a[164:167], v[208:211], v[4:7]
v_exp_f32 v201, v201
v_mfma_f32_16x16x32_bf16 v[8:11], a[168:171], v[208:211], v[8:11]
v_cvt_pk_bf16_f32 v212, v200, v201
v_add_f32 v218, v218, v195
v_mfma_f32_16x16x32_bf16 v[12:15], a[172:175], v[208:211], v[12:15]
s_add_u32 m0, s34, s45
v_exp_f32 v202, v202
v_mfma_f32_16x16x32_bf16 v[16:19], a[176:179], v[208:211], v[16:19]
buffer_load_dwordx4 v229, s[24:27], s35 offen nt lds
v_mfma_f32_16x16x32_bf16 v[20:23], a[180:183], v[208:211], v[20:23]
v_exp_f32 v203, v203
v_mfma_f32_16x16x32_bf16 v[24:27], a[184:187], v[208:211], v[24:27]
s_add_u32 s35, s35, 8192
v_cvt_pk_bf16_f32 v213, v202, v203
v_add_f32 v218, v218, v196
v_mfma_f32_16x16x32_bf16 v[28:31], a[188:191], v[208:211], v[28:31]
s_cmp_lt_u32 s35, 131072
v_exp_f32 v204, v204
v_mfma_f32_16x16x32_bf16 v[192:195], a[128:131], a[64:67], 0
s_cselect_b32 s22, 131072, 0
v_add_f32 v218, v218, v197
v_add_f32 v218, v218, v198
v_mfma_f32_16x16x32_bf16 v[192:195], a[132:135], a[68:71], v[192:195]
s_cselect_b32 s26, 131072, 0
v_exp_f32 v205, v205
v_mfma_f32_16x16x32_bf16 v[192:195], a[136:139], a[72:75], v[192:195]
s_add_u32 s34, s34, 17152
v_cvt_pk_bf16_f32 v214, v204, v205
v_add_f32 v218, v218, v199
v_mfma_f32_16x16x32_bf16 v[192:195], a[140:143], a[76:79], v[192:195]
s_cmp_eq_u32 s34, s51
v_exp_f32 v206, v206
v_mfma_f32_16x16x32_bf16 v[196:199], a[144:147], a[64:67], 0
s_cselect_b32 s34, s46, s34
v_add_f32 v219, v219, v200
v_add_f32 v219, v219, v201
v_mfma_f32_16x16x32_bf16 v[196:199], a[148:151], a[68:71], v[196:199]
v_exp_f32 v207, v207
v_mfma_f32_16x16x32_bf16 v[196:199], a[152:155], a[72:75], v[196:199]
v_cvt_pk_bf16_f32 v215, v206, v207
v_add_f32 v219, v219, v202
v_mfma_f32_16x16x32_bf16 v[196:199], a[156:159], a[76:79], v[196:199]
v_exp_f32 v192, v192
v_mfma_f32_16x16x32_bf16 v[32:35], a[160:163], v[212:215], v[32:35]
v_add_f32 v219, v219, v203
v_add_f32 v219, v219, v204
v_mfma_f32_16x16x32_bf16 v[36:39], a[164:167], v[212:215], v[36:39]
v_exp_f32 v193, v193
v_mfma_f32_16x16x32_bf16 v[40:43], a[168:171], v[212:215], v[40:43]
v_cvt_pk_bf16_f32 v208, v192, v193
v_add_f32 v219, v219, v205
v_mfma_f32_16x16x32_bf16 v[44:47], a[172:175], v[212:215], v[44:47]
v_exp_f32 v194, v194
v_mfma_f32_16x16x32_bf16 v[48:51], a[176:179], v[212:215], v[48:51]
v_add_f32 v219, v219, v206
v_add_f32 v219, v219, v207
v_mfma_f32_16x16x32_bf16 v[52:55], a[180:183], v[212:215], v[52:55]
v_exp_f32 v195, v195
v_mfma_f32_16x16x32_bf16 v[56:59], a[184:187], v[212:215], v[56:59]
v_cvt_pk_bf16_f32 v209, v194, v195
v_add_f32 v220, v220, v192
v_mfma_f32_16x16x32_bf16 v[60:63], a[188:191], v[212:215], v[60:63]
v_exp_f32 v196, v196
v_mfma_f32_16x16x32_bf16 v[200:203], a[128:131], a[80:83], 0
v_add_f32 v220, v220, v193
v_add_f32 v220, v220, v194
v_mfma_f32_16x16x32_bf16 v[200:203], a[132:135], a[84:87], v[200:203]
v_exp_f32 v197, v197
v_mfma_f32_16x16x32_bf16 v[200:203], a[136:139], a[88:91], v[200:203]
v_cvt_pk_bf16_f32 v210, v196, v197
v_add_f32 v220, v220, v195
v_mfma_f32_16x16x32_bf16 v[200:203], a[140:143], a[92:95], v[200:203]
v_exp_f32 v198, v198
v_mfma_f32_16x16x32_bf16 v[204:207], a[144:147], a[80:83], 0
s_add_u32 s37, s37, 1
v_add_f32 v220, v220, v196
v_add_f32 v220, v220, v197
v_mfma_f32_16x16x32_bf16 v[204:207], a[148:151], a[84:87], v[204:207]
s_cmp_eq_u32 s37, 4
v_exp_f32 v199, v199
v_mfma_f32_16x16x32_bf16 v[204:207], a[152:155], a[88:91], v[204:207]
s_cselect_b32 s37, 0, s37
v_cvt_pk_bf16_f32 v211, v198, v199
v_add_f32 v220, v220, v198
v_mfma_f32_16x16x32_bf16 v[204:207], a[156:159], a[92:95], v[204:207]
s_cselect_b32 s36, 4294915840, s42
v_exp_f32 v200, v200
v_mfma_f32_16x16x32_bf16 v[64:67], a[160:163], v[208:211], v[64:67]
v_add_f32 v220, v220, v199
v_add_f32 v221, v221, v200
v_mfma_f32_16x16x32_bf16 v[68:71], a[164:167], v[208:211], v[68:71]
v_exp_f32 v201, v201
v_mfma_f32_16x16x32_bf16 v[72:75], a[168:171], v[208:211], v[72:75]
v_cvt_pk_bf16_f32 v212, v200, v201
v_add_f32 v221, v221, v201
v_mfma_f32_16x16x32_bf16 v[76:79], a[172:175], v[208:211], v[76:79]
v_exp_f32 v202, v202
v_mfma_f32_16x16x32_bf16 v[80:83], a[176:179], v[208:211], v[80:83]
v_add_f32 v221, v221, v202
v_mfma_f32_16x16x32_bf16 v[84:87], a[180:183], v[208:211], v[84:87]
v_exp_f32 v203, v203
v_mfma_f32_16x16x32_bf16 v[88:91], a[184:187], v[208:211], v[88:91]
v_cvt_pk_bf16_f32 v213, v202, v203
v_add_f32 v221, v221, v203
v_mfma_f32_16x16x32_bf16 v[92:95], a[188:191], v[208:211], v[92:95]
v_exp_f32 v204, v204
v_mfma_f32_16x16x32_bf16 v[192:195], a[128:131], a[96:99], 0
v_add_f32 v221, v221, v204
v_mfma_f32_16x16x32_bf16 v[192:195], a[132:135], a[100:103], v[192:195]
v_exp_f32 v205, v205
v_mfma_f32_16x16x32_bf16 v[192:195], a[136:139], a[104:107], v[192:195]
v_cvt_pk_bf16_f32 v214, v204, v205
v_add_f32 v221, v221, v205
v_mfma_f32_16x16x32_bf16 v[192:195], a[140:143], a[108:111], v[192:195]
v_exp_f32 v206, v206
v_mfma_f32_16x16x32_bf16 v[196:199], a[144:147], a[96:99], 0
v_add_f32 v221, v221, v206
v_mfma_f32_16x16x32_bf16 v[196:199], a[148:151], a[100:103], v[196:199]
v_exp_f32 v207, v207
v_mfma_f32_16x16x32_bf16 v[196:199], a[152:155], a[104:107], v[196:199]
s_waitcnt vmcnt(8)
v_cvt_pk_bf16_f32 v215, v206, v207
v_add_f32 v221, v221, v207
v_mfma_f32_16x16x32_bf16 v[196:199], a[156:159], a[108:111], v[196:199]
v_exp_f32 v192, v192
v_mfma_f32_16x16x32_bf16 v[96:99], a[160:163], v[212:215], v[96:99]
s_barrier
v_add_f32 v222, v222, v192
v_mfma_f32_16x16x32_bf16 v[100:103], a[164:167], v[212:215], v[100:103]
v_exp_f32 v193, v193
v_mfma_f32_16x16x32_bf16 v[104:107], a[168:171], v[212:215], v[104:107]
v_cvt_pk_bf16_f32 v208, v192, v193
v_add_f32 v222, v222, v193
v_mfma_f32_16x16x32_bf16 v[108:111], a[172:175], v[212:215], v[108:111]
v_exp_f32 v194, v194
v_mfma_f32_16x16x32_bf16 v[112:115], a[176:179], v[212:215], v[112:115]
v_add_f32 v222, v222, v194
v_mfma_f32_16x16x32_bf16 v[116:119], a[180:183], v[212:215], v[116:119]
v_exp_f32 v195, v195
v_mfma_f32_16x16x32_bf16 v[120:123], a[184:187], v[212:215], v[120:123]
v_cvt_pk_bf16_f32 v209, v194, v195
v_add_f32 v222, v222, v195
v_mfma_f32_16x16x32_bf16 v[124:127], a[188:191], v[212:215], v[124:127]
v_exp_f32 v196, v196
v_mfma_f32_16x16x32_bf16 v[200:203], a[128:131], a[112:115], 0
ds_read_b128 a[128:131], v224 offset:0
v_add_f32 v222, v222, v196
v_mfma_f32_16x16x32_bf16 v[200:203], a[132:135], a[116:119], v[200:203]
v_exp_f32 v197, v197
v_mfma_f32_16x16x32_bf16 v[200:203], a[136:139], a[120:123], v[200:203]
ds_read_b128 a[132:135], v224 offset:64
v_cvt_pk_bf16_f32 v210, v196, v197
v_mfma_f32_16x16x32_bf16 v[200:203], a[140:143], a[124:127], v[200:203]
v_exp_f32 v198, v198
v_mfma_f32_16x16x32_bf16 v[204:207], a[144:147], a[112:115], 0
ds_read_b128 a[136:139], v224 offset:128
v_add_f32 v222, v222, v197
v_mfma_f32_16x16x32_bf16 v[204:207], a[148:151], a[116:119], v[204:207]
v_exp_f32 v199, v199
v_mfma_f32_16x16x32_bf16 v[204:207], a[152:155], a[120:123], v[204:207]
ds_read_b128 a[140:143], v224 offset:192
v_cvt_pk_bf16_f32 v211, v198, v199
v_mfma_f32_16x16x32_bf16 v[204:207], a[156:159], a[124:127], v[204:207]
v_exp_f32 v200, v200
v_mfma_f32_16x16x32_bf16 v[128:131], a[160:163], v[208:211], v[128:131]
ds_read_b128 a[144:147], v224 offset:4352
v_add_f32 v222, v222, v198
v_add_f32 v223, v223, v200
v_mfma_f32_16x16x32_bf16 v[132:135], a[164:167], v[208:211], v[132:135]
v_exp_f32 v201, v201
v_mfma_f32_16x16x32_bf16 v[136:139], a[168:171], v[208:211], v[136:139]
ds_read_b128 a[148:151], v224 offset:4416
v_cvt_pk_bf16_f32 v212, v200, v201
v_mfma_f32_16x16x32_bf16 v[140:143], a[172:175], v[208:211], v[140:143]
v_exp_f32 v202, v202
v_mfma_f32_16x16x32_bf16 v[144:147], a[176:179], v[208:211], v[144:147]
ds_read_b128 a[152:155], v224 offset:4480
v_add_f32 v222, v222, v199
v_mfma_f32_16x16x32_bf16 v[148:151], a[180:183], v[208:211], v[148:151]
s_waitcnt lgkmcnt(3)
v_exp_f32 v203, v203
v_mfma_f32_16x16x32_bf16 v[152:155], a[184:187], v[208:211], v[152:155]
s_cmp_lt_u32 s35, 139264
ds_read_b128 a[156:159], v224 offset:4544
v_cvt_pk_bf16_f32 v213, v202, v203
v_mfma_f32_16x16x32_bf16 v[156:159], a[188:191], v[208:211], v[156:159]
s_cbranch_scc1 L_loop
L_final:
v_exp_f32 v204, v204
v_mbcnt_lo_u32_b32 v240, -1, 0
v_mbcnt_hi_u32_b32 v240, -1, v240
v_and_b32 v241, 15, v240
v_lshrrev_b32 v242, 4, v240
v_mul_u32_u24 v226, 272, v241
v_lshl_add_u32 v226, v242, 3, v226
v_add_u32 v226, s47, v226
v_mul_u32_u24 v227, 272, v242
v_lshl_add_u32 v227, v241, 4, v227
v_add_u32 v227, s47, v227
s_lshl_b32 s41, s3, 15
v_lshlrev_b32 v229, 4, v240
v_add_u32 v229, s41, v229
v_mfma_f32_16x16x32_bf16 v[192:195], a[128:131], a[0:3], 0
v_add_f32 v223, v223, v201
v_add_f32 v223, v223, v202
v_mfma_f32_16x16x32_bf16 v[192:195], a[132:135], a[4:7], v[192:195]
v_exp_f32 v205, v205
v_mfma_f32_16x16x32_bf16 v[192:195], a[136:139], a[8:11], v[192:195]
v_cvt_pk_bf16_f32 v214, v204, v205
v_add_f32 v223, v223, v203
v_mfma_f32_16x16x32_bf16 v[192:195], a[140:143], a[12:15], v[192:195]
s_waitcnt lgkmcnt(1)
v_exp_f32 v206, v206
v_mfma_f32_16x16x32_bf16 v[196:199], a[144:147], a[0:3], 0
v_add_f32 v223, v223, v204
v_add_f32 v223, v223, v205
v_mfma_f32_16x16x32_bf16 v[196:199], a[148:151], a[4:7], v[196:199]
v_exp_f32 v207, v207
v_mfma_f32_16x16x32_bf16 v[196:199], a[152:155], a[8:11], v[196:199]
s_waitcnt lgkmcnt(0)
v_cvt_pk_bf16_f32 v215, v206, v207
v_add_f32 v223, v223, v206
v_mfma_f32_16x16x32_bf16 v[196:199], a[156:159], a[12:15], v[196:199]
v_exp_f32 v192, v192
v_mfma_f32_16x16x32_bf16 v[160:163], a[160:163], v[212:215], v[160:163]
ds_read_b64_tr_b16 a[160:161], v225 offset:0
v_add_f32 v223, v223, v207
v_mfma_f32_16x16x32_bf16 v[164:167], a[164:167], v[212:215], v[164:167]
ds_read_b64_tr_b16 a[162:163], v225 offset:512
v_exp_f32 v193, v193
v_mfma_f32_16x16x32_bf16 v[168:171], a[168:171], v[212:215], v[168:171]
ds_read_b64_tr_b16 a[164:165], v225 offset:32
v_cvt_pk_bf16_f32 v208, v192, v193
v_mfma_f32_16x16x32_bf16 v[172:175], a[172:175], v[212:215], v[172:175]
ds_read_b64_tr_b16 a[166:167], v225 offset:544
v_exp_f32 v194, v194
v_mfma_f32_16x16x32_bf16 v[176:179], a[176:179], v[212:215], v[176:179]
ds_read_b64_tr_b16 a[168:169], v225 offset:64
v_add_f32 v216, v216, v192
v_mfma_f32_16x16x32_bf16 v[180:183], a[180:183], v[212:215], v[180:183]
ds_read_b64_tr_b16 a[170:171], v225 offset:576
v_exp_f32 v195, v195
v_mfma_f32_16x16x32_bf16 v[184:187], a[184:187], v[212:215], v[184:187]
ds_read_b64_tr_b16 a[172:173], v225 offset:96
v_cvt_pk_bf16_f32 v209, v194, v195
v_mfma_f32_16x16x32_bf16 v[188:191], a[188:191], v[212:215], v[188:191]
v_exp_f32 v196, v196
v_mfma_f32_16x16x32_bf16 v[200:203], a[128:131], a[16:19], 0
ds_read_b64_tr_b16 a[174:175], v225 offset:608
v_add_f32 v216, v216, v193
v_mfma_f32_16x16x32_bf16 v[200:203], a[132:135], a[20:23], v[200:203]
ds_read_b64_tr_b16 a[176:177], v225 offset:128
v_exp_f32 v197, v197
v_mfma_f32_16x16x32_bf16 v[200:203], a[136:139], a[24:27], v[200:203]
ds_read_b64_tr_b16 a[178:179], v225 offset:640
v_cvt_pk_bf16_f32 v210, v196, v197
v_mfma_f32_16x16x32_bf16 v[200:203], a[140:143], a[28:31], v[200:203]
ds_read_b64_tr_b16 a[180:181], v225 offset:160
v_exp_f32 v198, v198
v_mfma_f32_16x16x32_bf16 v[204:207], a[144:147], a[16:19], 0
ds_read_b64_tr_b16 a[182:183], v225 offset:672
v_add_f32 v216, v216, v194
v_mfma_f32_16x16x32_bf16 v[204:207], a[148:151], a[20:23], v[204:207]
v_exp_f32 v199, v199
v_mfma_f32_16x16x32_bf16 v[204:207], a[152:155], a[24:27], v[204:207]
ds_read_b64_tr_b16 a[184:185], v225 offset:192
v_cvt_pk_bf16_f32 v211, v198, v199
v_mfma_f32_16x16x32_bf16 v[204:207], a[156:159], a[28:31], v[204:207]
s_waitcnt lgkmcnt(7)
ds_read_b64_tr_b16 a[186:187], v225 offset:704
v_exp_f32 v200, v200
v_mfma_f32_16x16x32_bf16 a[192:195], a[160:163], v[208:211], a[192:195]
ds_read_b64_tr_b16 a[188:189], v225 offset:224
v_add_f32 v216, v216, v195
v_mfma_f32_16x16x32_bf16 a[196:199], a[164:167], v[208:211], a[196:199]
v_exp_f32 v201, v201
v_mfma_f32_16x16x32_bf16 a[200:203], a[168:171], v[208:211], a[200:203]
s_waitcnt lgkmcnt(5)
ds_read_b64_tr_b16 a[190:191], v225 offset:736
v_cvt_pk_bf16_f32 v212, v200, v201
v_mfma_f32_16x16x32_bf16 a[204:207], a[172:175], v[208:211], a[204:207]
v_exp_f32 v202, v202
v_mfma_f32_16x16x32_bf16 a[208:211], a[176:179], v[208:211], a[208:211]
s_waitcnt lgkmcnt(4)
v_add_f32 v216, v216, v196
v_add_f32 v216, v216, v197
v_mfma_f32_16x16x32_bf16 a[212:215], a[180:183], v[208:211], a[212:215]
s_waitcnt lgkmcnt(2)
v_exp_f32 v203, v203
v_mfma_f32_16x16x32_bf16 a[216:219], a[184:187], v[208:211], a[216:219]
s_waitcnt lgkmcnt(0)
v_cvt_pk_bf16_f32 v213, v202, v203
v_add_f32 v216, v216, v198
v_mfma_f32_16x16x32_bf16 a[220:223], a[188:191], v[208:211], a[220:223]
v_exp_f32 v204, v204
v_mfma_f32_16x16x32_bf16 v[192:195], a[128:131], a[32:35], 0
v_add_f32 v216, v216, v199
v_add_f32 v217, v217, v200
v_mfma_f32_16x16x32_bf16 v[192:195], a[132:135], a[36:39], v[192:195]
v_exp_f32 v205, v205
v_mfma_f32_16x16x32_bf16 v[192:195], a[136:139], a[40:43], v[192:195]
v_cvt_pk_bf16_f32 v214, v204, v205
v_add_f32 v217, v217, v201
v_mfma_f32_16x16x32_bf16 v[192:195], a[140:143], a[44:47], v[192:195]
v_exp_f32 v206, v206
v_mfma_f32_16x16x32_bf16 v[196:199], a[144:147], a[32:35], 0
s_waitcnt vmcnt(4)
v_add_f32 v217, v217, v202
v_add_f32 v217, v217, v203
v_mfma_f32_16x16x32_bf16 v[196:199], a[148:151], a[36:39], v[196:199]
v_exp_f32 v207, v207
v_mfma_f32_16x16x32_bf16 v[196:199], a[152:155], a[40:43], v[196:199]
s_barrier
v_cvt_pk_bf16_f32 v215, v206, v207
v_add_f32 v217, v217, v204
v_mfma_f32_16x16x32_bf16 v[196:199], a[156:159], a[44:47], v[196:199]
v_exp_f32 v192, v192
v_mfma_f32_16x16x32_bf16 a[224:227], a[160:163], v[212:215], a[224:227]
v_add_f32 v217, v217, v205
v_add_f32 v217, v217, v206
v_mfma_f32_16x16x32_bf16 a[228:231], a[164:167], v[212:215], a[228:231]
v_exp_f32 v193, v193
v_mfma_f32_16x16x32_bf16 a[232:235], a[168:171], v[212:215], a[232:235]
v_cvt_pk_bf16_f32 v208, v192, v193
v_add_f32 v217, v217, v207
v_mfma_f32_16x16x32_bf16 a[236:239], a[172:175], v[212:215], a[236:239]
v_exp_f32 v194, v194
v_mfma_f32_16x16x32_bf16 a[240:243], a[176:179], v[212:215], a[240:243]
v_add_f32 v218, v218, v192
v_add_f32 v218, v218, v193
v_mfma_f32_16x16x32_bf16 a[244:247], a[180:183], v[212:215], a[244:247]
v_exp_f32 v195, v195
v_mfma_f32_16x16x32_bf16 a[248:251], a[184:187], v[212:215], a[248:251]
v_cvt_pk_bf16_f32 v209, v194, v195
v_add_f32 v218, v218, v194
v_mfma_f32_16x16x32_bf16 a[252:255], a[188:191], v[212:215], a[252:255]
v_exp_f32 v196, v196
v_mfma_f32_16x16x32_bf16 v[200:203], a[128:131], a[48:51], 0
ds_read_b128 a[128:131], v224 offset:17152
v_add_f32 v218, v218, v195
v_mfma_f32_16x16x32_bf16 v[200:203], a[132:135], a[52:55], v[200:203]
v_exp_f32 v197, v197
v_mfma_f32_16x16x32_bf16 v[200:203], a[136:139], a[56:59], v[200:203]
ds_read_b128 a[132:135], v224 offset:17216
v_cvt_pk_bf16_f32 v210, v196, v197
v_mfma_f32_16x16x32_bf16 v[200:203], a[140:143], a[60:63], v[200:203]
v_exp_f32 v198, v198
v_mfma_f32_16x16x32_bf16 v[204:207], a[144:147], a[48:51], 0
ds_read_b128 a[136:139], v224 offset:17280
v_add_f32 v218, v218, v196
v_mfma_f32_16x16x32_bf16 v[204:207], a[148:151], a[52:55], v[204:207]
v_exp_f32 v199, v199
v_mfma_f32_16x16x32_bf16 v[204:207], a[152:155], a[56:59], v[204:207]
ds_read_b128 a[140:143], v224 offset:17344
v_cvt_pk_bf16_f32 v211, v198, v199
v_mfma_f32_16x16x32_bf16 v[204:207], a[156:159], a[60:63], v[204:207]
v_exp_f32 v200, v200
v_mfma_f32_16x16x32_bf16 v[0:3], a[160:163], v[208:211], v[0:3]
ds_read_b128 a[144:147], v224 offset:21504
v_add_f32 v218, v218, v197
v_mfma_f32_16x16x32_bf16 v[4:7], a[164:167], v[208:211], v[4:7]
v_exp_f32 v201, v201
v_mfma_f32_16x16x32_bf16 v[8:11], a[168:171], v[208:211], v[8:11]
ds_read_b128 a[148:151], v224 offset:21568
v_cvt_pk_bf16_f32 v212, v200, v201
v_mfma_f32_16x16x32_bf16 v[12:15], a[172:175], v[208:211], v[12:15]
v_exp_f32 v202, v202
v_mfma_f32_16x16x32_bf16 v[16:19], a[176:179], v[208:211], v[16:19]
ds_read_b128 a[152:155], v224 offset:21632
v_add_f32 v218, v218, v198
v_mfma_f32_16x16x32_bf16 v[20:23], a[180:183], v[208:211], v[20:23]
s_waitcnt lgkmcnt(3)
v_exp_f32 v203, v203
v_mfma_f32_16x16x32_bf16 v[24:27], a[184:187], v[208:211], v[24:27]
ds_read_b128 a[156:159], v224 offset:21696
v_cvt_pk_bf16_f32 v213, v202, v203
v_mfma_f32_16x16x32_bf16 v[28:31], a[188:191], v[208:211], v[28:31]
v_exp_f32 v204, v204
v_mfma_f32_16x16x32_bf16 v[192:195], a[128:131], a[0:3], 0
v_add_f32 v218, v218, v199
v_add_f32 v219, v219, v200
v_mfma_f32_16x16x32_bf16 v[192:195], a[132:135], a[4:7], v[192:195]
v_exp_f32 v205, v205
v_mfma_f32_16x16x32_bf16 v[192:195], a[136:139], a[8:11], v[192:195]
v_cvt_pk_bf16_f32 v214, v204, v205
v_add_f32 v219, v219, v201
v_mfma_f32_16x16x32_bf16 v[192:195], a[140:143], a[12:15], v[192:195]
s_waitcnt lgkmcnt(1)
v_exp_f32 v206, v206
v_mfma_f32_16x16x32_bf16 v[196:199], a[144:147], a[0:3], 0
v_add_f32 v219, v219, v202
v_add_f32 v219, v219, v203
v_mfma_f32_16x16x32_bf16 v[196:199], a[148:151], a[4:7], v[196:199]
v_exp_f32 v207, v207
v_mfma_f32_16x16x32_bf16 v[196:199], a[152:155], a[8:11], v[196:199]
s_waitcnt lgkmcnt(0)
v_cvt_pk_bf16_f32 v215, v206, v207
v_add_f32 v219, v219, v204
v_mfma_f32_16x16x32_bf16 v[196:199], a[156:159], a[12:15], v[196:199]
v_exp_f32 v192, v192
v_mfma_f32_16x16x32_bf16 v[32:35], a[160:163], v[212:215], v[32:35]
ds_read_b64_tr_b16 a[160:161], v225 offset:17152
v_add_f32 v219, v219, v205
v_mfma_f32_16x16x32_bf16 v[36:39], a[164:167], v[212:215], v[36:39]
ds_read_b64_tr_b16 a[162:163], v225 offset:17664
v_exp_f32 v193, v193
v_mfma_f32_16x16x32_bf16 v[40:43], a[168:171], v[212:215], v[40:43]
ds_read_b64_tr_b16 a[164:165], v225 offset:17184
v_cvt_pk_bf16_f32 v208, v192, v193
v_mfma_f32_16x16x32_bf16 v[44:47], a[172:175], v[212:215], v[44:47]
ds_read_b64_tr_b16 a[166:167], v225 offset:17696
v_exp_f32 v194, v194
v_mfma_f32_16x16x32_bf16 v[48:51], a[176:179], v[212:215], v[48:51]
ds_read_b64_tr_b16 a[168:169], v225 offset:17216
v_add_f32 v219, v219, v206
v_add_f32 v216, v216, v194
v_mfma_f32_16x16x32_bf16 v[52:55], a[180:183], v[212:215], v[52:55]
ds_read_b64_tr_b16 a[170:171], v225 offset:17728
v_exp_f32 v195, v195
v_mfma_f32_16x16x32_bf16 v[56:59], a[184:187], v[212:215], v[56:59]
ds_read_b64_tr_b16 a[172:173], v225 offset:17248
v_cvt_pk_bf16_f32 v209, v194, v195
v_add_f32 v216, v216, v195
v_mfma_f32_16x16x32_bf16 v[60:63], a[188:191], v[212:215], v[60:63]
v_exp_f32 v196, v196
v_mfma_f32_16x16x32_bf16 v[200:203], a[128:131], a[16:19], 0
ds_read_b64_tr_b16 a[174:175], v225 offset:17760
v_add_f32 v219, v219, v207
v_add_f32 v216, v216, v196
v_mfma_f32_16x16x32_bf16 v[200:203], a[132:135], a[20:23], v[200:203]
ds_read_b64_tr_b16 a[176:177], v225 offset:17280
v_exp_f32 v197, v197
v_mfma_f32_16x16x32_bf16 v[200:203], a[136:139], a[24:27], v[200:203]
ds_read_b64_tr_b16 a[178:179], v225 offset:17792
v_cvt_pk_bf16_f32 v210, v196, v197
v_add_f32 v216, v216, v197
v_mfma_f32_16x16x32_bf16 v[200:203], a[140:143], a[28:31], v[200:203]
ds_read_b64_tr_b16 a[180:181], v225 offset:17312
v_exp_f32 v198, v198
v_mfma_f32_16x16x32_bf16 v[204:207], a[144:147], a[16:19], 0
ds_read_b64_tr_b16 a[182:183], v225 offset:17824
v_add_f32 v216, v216, v192
v_add_f32 v216, v216, v198
v_mfma_f32_16x16x32_bf16 v[204:207], a[148:151], a[20:23], v[204:207]
v_exp_f32 v199, v199
v_mfma_f32_16x16x32_bf16 v[204:207], a[152:155], a[24:27], v[204:207]
ds_read_b64_tr_b16 a[184:185], v225 offset:17344
v_cvt_pk_bf16_f32 v211, v198, v199
v_add_f32 v216, v216, v199
v_mfma_f32_16x16x32_bf16 v[204:207], a[156:159], a[28:31], v[204:207]
s_waitcnt lgkmcnt(7)
ds_read_b64_tr_b16 a[186:187], v225 offset:17856
v_exp_f32 v200, v200
v_mfma_f32_16x16x32_bf16 a[192:195], a[160:163], v[208:211], a[192:195]
ds_read_b64_tr_b16 a[188:189], v225 offset:17376
v_add_f32 v216, v216, v193
v_mfma_f32_16x16x32_bf16 a[196:199], a[164:167], v[208:211], a[196:199]
v_exp_f32 v201, v201
v_mfma_f32_16x16x32_bf16 a[200:203], a[168:171], v[208:211], a[200:203]
s_waitcnt lgkmcnt(5)
ds_read_b64_tr_b16 a[190:191], v225 offset:17888
v_cvt_pk_bf16_f32 v212, v200, v201
v_mov_b32 v230, v216
v_mfma_f32_16x16x32_bf16 a[204:207], a[172:175], v[208:211], a[204:207]
v_exp_f32 v202, v202
v_mfma_f32_16x16x32_bf16 a[208:211], a[176:179], v[208:211], a[208:211]
s_waitcnt lgkmcnt(4)
v_add_f32 v217, v217, v200
v_add_f32 v217, v217, v201
v_permlane32_swap_b32 v216, v230
v_mfma_f32_16x16x32_bf16 a[212:215], a[180:183], v[208:211], a[212:215]
s_waitcnt lgkmcnt(2)
v_exp_f32 v203, v203
v_mfma_f32_16x16x32_bf16 a[216:219], a[184:187], v[208:211], a[216:219]
s_waitcnt lgkmcnt(0)
v_cvt_pk_bf16_f32 v213, v202, v203
v_add_f32 v217, v217, v202
v_add_f32 v216, v216, v230
v_mfma_f32_16x16x32_bf16 a[220:223], a[188:191], v[208:211], a[220:223]
v_exp_f32 v204, v204
v_mfma_f32_16x16x32_bf16 v[192:195], a[128:131], a[32:35], 0
v_add_f32 v217, v217, v203
v_add_f32 v217, v217, v204
v_mov_b32 v230, v216
v_mfma_f32_16x16x32_bf16 v[192:195], a[132:135], a[36:39], v[192:195]
v_exp_f32 v205, v205
v_mfma_f32_16x16x32_bf16 v[192:195], a[136:139], a[40:43], v[192:195]
v_cvt_pk_bf16_f32 v214, v204, v205
v_add_f32 v217, v217, v205
v_permlane16_swap_b32 v216, v230
v_mfma_f32_16x16x32_bf16 v[192:195], a[140:143], a[44:47], v[192:195]
v_exp_f32 v206, v206
v_mfma_f32_16x16x32_bf16 v[196:199], a[144:147], a[32:35], 0
v_add_f32 v217, v217, v206
v_add_f32 v216, v216, v230
v_mfma_f32_16x16x32_bf16 v[196:199], a[148:151], a[36:39], v[196:199]
v_exp_f32 v207, v207
v_mfma_f32_16x16x32_bf16 v[196:199], a[152:155], a[40:43], v[196:199]
v_cvt_pk_bf16_f32 v215, v206, v207
v_add_f32 v217, v217, v207
v_rcp_f32 v228, v216
v_mfma_f32_16x16x32_bf16 v[196:199], a[156:159], a[44:47], v[196:199]
v_exp_f32 v192, v192
v_accvgpr_read_b32 v232, a192
v_accvgpr_read_b32 v233, a193
v_accvgpr_read_b32 v234, a194
v_accvgpr_read_b32 v235, a195
v_pk_mul_f32 v[232:233], v[232:233], v[228:229] op_sel_hi:[1,0]
v_pk_mul_f32 v[234:235], v[234:235], v[228:229] op_sel_hi:[1,0]
v_cvt_pk_bf16_f32 v232, v232, v233
v_cvt_pk_bf16_f32 v233, v234, v235
ds_write_b64 v226, v[232:233] offset:0
v_accvgpr_read_b32 v236, a196
v_accvgpr_read_b32 v237, a197
v_accvgpr_read_b32 v238, a198
v_accvgpr_read_b32 v239, a199
v_pk_mul_f32 v[236:237], v[236:237], v[228:229] op_sel_hi:[1,0]
v_pk_mul_f32 v[238:239], v[238:239], v[228:229] op_sel_hi:[1,0]
v_cvt_pk_bf16_f32 v236, v236, v237
v_cvt_pk_bf16_f32 v237, v238, v239
ds_write_b64 v226, v[236:237] offset:32
v_accvgpr_read_b32 v232, a200
v_accvgpr_read_b32 v233, a201
v_accvgpr_read_b32 v234, a202
v_accvgpr_read_b32 v235, a203
v_pk_mul_f32 v[232:233], v[232:233], v[228:229] op_sel_hi:[1,0]
v_pk_mul_f32 v[234:235], v[234:235], v[228:229] op_sel_hi:[1,0]
v_cvt_pk_bf16_f32 v232, v232, v233
v_cvt_pk_bf16_f32 v233, v234, v235
ds_write_b64 v226, v[232:233] offset:64
v_accvgpr_read_b32 v236, a204
v_accvgpr_read_b32 v237, a205
v_accvgpr_read_b32 v238, a206
v_accvgpr_read_b32 v239, a207
v_pk_mul_f32 v[236:237], v[236:237], v[228:229] op_sel_hi:[1,0]
v_pk_mul_f32 v[238:239], v[238:239], v[228:229] op_sel_hi:[1,0]
v_cvt_pk_bf16_f32 v236, v236, v237
v_cvt_pk_bf16_f32 v237, v238, v239
ds_write_b64 v226, v[236:237] offset:96
v_accvgpr_read_b32 v232, a208
v_accvgpr_read_b32 v233, a209
v_accvgpr_read_b32 v234, a210
v_accvgpr_read_b32 v235, a211
v_pk_mul_f32 v[232:233], v[232:233], v[228:229] op_sel_hi:[1,0]
v_pk_mul_f32 v[234:235], v[234:235], v[228:229] op_sel_hi:[1,0]
v_cvt_pk_bf16_f32 v232, v232, v233
v_cvt_pk_bf16_f32 v233, v234, v235
ds_write_b64 v226, v[232:233] offset:128
v_accvgpr_read_b32 v236, a212
v_accvgpr_read_b32 v237, a213
v_accvgpr_read_b32 v238, a214
v_accvgpr_read_b32 v239, a215
v_pk_mul_f32 v[236:237], v[236:237], v[228:229] op_sel_hi:[1,0]
v_pk_mul_f32 v[238:239], v[238:239], v[228:229] op_sel_hi:[1,0]
v_cvt_pk_bf16_f32 v236, v236, v237
v_cvt_pk_bf16_f32 v237, v238, v239
ds_write_b64 v226, v[236:237] offset:160
v_accvgpr_read_b32 v232, a216
v_accvgpr_read_b32 v233, a217
v_accvgpr_read_b32 v234, a218
v_accvgpr_read_b32 v235, a219
v_pk_mul_f32 v[232:233], v[232:233], v[228:229] op_sel_hi:[1,0]
v_pk_mul_f32 v[234:235], v[234:235], v[228:229] op_sel_hi:[1,0]
v_cvt_pk_bf16_f32 v232, v232, v233
v_cvt_pk_bf16_f32 v233, v234, v235
ds_write_b64 v226, v[232:233] offset:192
v_accvgpr_read_b32 v236, a220
v_accvgpr_read_b32 v237, a221
v_accvgpr_read_b32 v238, a222
v_accvgpr_read_b32 v239, a223
v_pk_mul_f32 v[236:237], v[236:237], v[228:229] op_sel_hi:[1,0]
v_pk_mul_f32 v[238:239], v[238:239], v[228:229] op_sel_hi:[1,0]
v_cvt_pk_bf16_f32 v236, v236, v237
v_cvt_pk_bf16_f32 v237, v238, v239
ds_write_b64 v226, v[236:237] offset:224
ds_read_b128 v[240:243], v227 offset:0
ds_read_b128 v[244:247], v227 offset:1088
ds_read_b128 v[248:251], v227 offset:2176
ds_read_b128 v[252:255], v227 offset:3264
v_mfma_f32_16x16x32_bf16 a[224:227], a[160:163], v[212:215], a[224:227]
v_add_f32 v218, v218, v192
v_mfma_f32_16x16x32_bf16 a[228:231], a[164:167], v[212:215], a[228:231]
v_exp_f32 v193, v193
v_mfma_f32_16x16x32_bf16 a[232:235], a[168:171], v[212:215], a[232:235]
v_cvt_pk_bf16_f32 v208, v192, v193
v_add_u32 v231, 0, v229
v_mov_b32 v230, v217
v_mfma_f32_16x16x32_bf16 a[236:239], a[172:175], v[212:215], a[236:239]
s_waitcnt lgkmcnt(0)
v_exp_f32 v194, v194
v_mfma_f32_16x16x32_bf16 a[240:243], a[176:179], v[212:215], a[240:243]
buffer_store_dwordx4 v[240:243], v231, s[28:31], 0 offen offset:0 nt
v_permlane32_swap_b32 v217, v230
v_mfma_f32_16x16x32_bf16 a[244:247], a[180:183], v[212:215], a[244:247]
v_exp_f32 v195, v195
v_mfma_f32_16x16x32_bf16 a[248:251], a[184:187], v[212:215], a[248:251]
v_cvt_pk_bf16_f32 v209, v194, v195
v_add_f32 v218, v218, v193
v_add_f32 v217, v217, v230
v_mfma_f32_16x16x32_bf16 a[252:255], a[188:191], v[212:215], a[252:255]
v_exp_f32 v196, v196
v_mfma_f32_16x16x32_bf16 v[200:203], a[128:131], a[48:51], 0
buffer_store_dwordx4 v[244:247], v231, s[28:31], 0 offen offset:1024 nt
v_mov_b32 v230, v217
v_mfma_f32_16x16x32_bf16 v[200:203], a[132:135], a[52:55], v[200:203]
v_exp_f32 v197, v197
v_mfma_f32_16x16x32_bf16 v[200:203], a[136:139], a[56:59], v[200:203]
v_cvt_pk_bf16_f32 v210, v196, v197
v_add_f32 v218, v218, v194
v_add_f32 v218, v218, v197
v_permlane16_swap_b32 v217, v230
v_mfma_f32_16x16x32_bf16 v[200:203], a[140:143], a[60:63], v[200:203]
v_exp_f32 v198, v198
v_mfma_f32_16x16x32_bf16 v[204:207], a[144:147], a[48:51], 0
buffer_store_dwordx4 v[248:251], v231, s[28:31], 0 offen offset:2048 nt
v_add_f32 v218, v218, v198
v_add_f32 v217, v217, v230
v_mfma_f32_16x16x32_bf16 v[204:207], a[148:151], a[52:55], v[204:207]
v_exp_f32 v199, v199
v_mfma_f32_16x16x32_bf16 v[204:207], a[152:155], a[56:59], v[204:207]
buffer_store_dwordx4 v[252:255], v231, s[28:31], 0 offen offset:3072 nt
v_cvt_pk_bf16_f32 v211, v198, v199
v_rcp_f32 v228, v217
v_mfma_f32_16x16x32_bf16 v[204:207], a[156:159], a[60:63], v[204:207]
v_exp_f32 v200, v200
v_add_f32 v218, v218, v199
v_accvgpr_read_b32 v232, a224
v_accvgpr_read_b32 v233, a225
v_accvgpr_read_b32 v234, a226
v_accvgpr_read_b32 v235, a227
v_pk_mul_f32 v[232:233], v[232:233], v[228:229] op_sel_hi:[1,0]
v_pk_mul_f32 v[234:235], v[234:235], v[228:229] op_sel_hi:[1,0]
v_cvt_pk_bf16_f32 v232, v232, v233
v_cvt_pk_bf16_f32 v233, v234, v235
ds_write_b64 v226, v[232:233] offset:0
v_accvgpr_read_b32 v236, a228
v_accvgpr_read_b32 v237, a229
v_accvgpr_read_b32 v238, a230
v_accvgpr_read_b32 v239, a231
v_pk_mul_f32 v[236:237], v[236:237], v[228:229] op_sel_hi:[1,0]
v_pk_mul_f32 v[238:239], v[238:239], v[228:229] op_sel_hi:[1,0]
v_cvt_pk_bf16_f32 v236, v236, v237
v_cvt_pk_bf16_f32 v237, v238, v239
ds_write_b64 v226, v[236:237] offset:32
v_accvgpr_read_b32 v232, a232
v_accvgpr_read_b32 v233, a233
v_accvgpr_read_b32 v234, a234
v_accvgpr_read_b32 v235, a235
v_pk_mul_f32 v[232:233], v[232:233], v[228:229] op_sel_hi:[1,0]
v_pk_mul_f32 v[234:235], v[234:235], v[228:229] op_sel_hi:[1,0]
v_cvt_pk_bf16_f32 v232, v232, v233
v_cvt_pk_bf16_f32 v233, v234, v235
ds_write_b64 v226, v[232:233] offset:64
v_accvgpr_read_b32 v236, a236
v_accvgpr_read_b32 v237, a237
v_accvgpr_read_b32 v238, a238
v_accvgpr_read_b32 v239, a239
v_pk_mul_f32 v[236:237], v[236:237], v[228:229] op_sel_hi:[1,0]
v_pk_mul_f32 v[238:239], v[238:239], v[228:229] op_sel_hi:[1,0]
v_cvt_pk_bf16_f32 v236, v236, v237
v_cvt_pk_bf16_f32 v237, v238, v239
ds_write_b64 v226, v[236:237] offset:96
v_accvgpr_read_b32 v232, a240
v_accvgpr_read_b32 v233, a241
v_accvgpr_read_b32 v234, a242
v_accvgpr_read_b32 v235, a243
v_pk_mul_f32 v[232:233], v[232:233], v[228:229] op_sel_hi:[1,0]
v_pk_mul_f32 v[234:235], v[234:235], v[228:229] op_sel_hi:[1,0]
v_cvt_pk_bf16_f32 v232, v232, v233
v_cvt_pk_bf16_f32 v233, v234, v235
ds_write_b64 v226, v[232:233] offset:128
v_accvgpr_read_b32 v236, a244
v_accvgpr_read_b32 v237, a245
v_accvgpr_read_b32 v238, a246
v_accvgpr_read_b32 v239, a247
v_pk_mul_f32 v[236:237], v[236:237], v[228:229] op_sel_hi:[1,0]
v_pk_mul_f32 v[238:239], v[238:239], v[228:229] op_sel_hi:[1,0]
v_cvt_pk_bf16_f32 v236, v236, v237
v_cvt_pk_bf16_f32 v237, v238, v239
ds_write_b64 v226, v[236:237] offset:160
v_accvgpr_read_b32 v232, a248
v_accvgpr_read_b32 v233, a249
v_accvgpr_read_b32 v234, a250
v_accvgpr_read_b32 v235, a251
v_pk_mul_f32 v[232:233], v[232:233], v[228:229] op_sel_hi:[1,0]
v_pk_mul_f32 v[234:235], v[234:235], v[228:229] op_sel_hi:[1,0]
v_cvt_pk_bf16_f32 v232, v232, v233
v_cvt_pk_bf16_f32 v233, v234, v235
ds_write_b64 v226, v[232:233] offset:192
v_accvgpr_read_b32 v236, a252
v_accvgpr_read_b32 v237, a253
v_accvgpr_read_b32 v238, a254
v_accvgpr_read_b32 v239, a255
v_pk_mul_f32 v[236:237], v[236:237], v[228:229] op_sel_hi:[1,0]
v_pk_mul_f32 v[238:239], v[238:239], v[228:229] op_sel_hi:[1,0]
v_cvt_pk_bf16_f32 v236, v236, v237
v_cvt_pk_bf16_f32 v237, v238, v239
ds_write_b64 v226, v[236:237] offset:224
ds_read_b128 v[240:243], v227 offset:0
ds_read_b128 v[244:247], v227 offset:1088
ds_read_b128 v[248:251], v227 offset:2176
ds_read_b128 v[252:255], v227 offset:3264
v_mfma_f32_16x16x32_bf16 v[0:3], a[160:163], v[208:211], v[0:3]
v_add_f32 v218, v218, v195
v_add_f32 v218, v218, v196
v_mfma_f32_16x16x32_bf16 v[4:7], a[164:167], v[208:211], v[4:7]
v_exp_f32 v201, v201
v_mfma_f32_16x16x32_bf16 v[8:11], a[168:171], v[208:211], v[8:11]
v_cvt_pk_bf16_f32 v212, v200, v201
v_add_u32 v231, 4096, v229
v_mov_b32 v230, v218
v_mfma_f32_16x16x32_bf16 v[12:15], a[172:175], v[208:211], v[12:15]
s_waitcnt lgkmcnt(0)
v_exp_f32 v202, v202
v_mfma_f32_16x16x32_bf16 v[16:19], a[176:179], v[208:211], v[16:19]
buffer_store_dwordx4 v[240:243], v231, s[28:31], 0 offen offset:0 nt
v_permlane32_swap_b32 v218, v230
v_mfma_f32_16x16x32_bf16 v[20:23], a[180:183], v[208:211], v[20:23]
v_exp_f32 v203, v203
v_mfma_f32_16x16x32_bf16 v[24:27], a[184:187], v[208:211], v[24:27]
v_cvt_pk_bf16_f32 v213, v202, v203
v_add_f32 v219, v219, v200
v_add_f32 v218, v218, v230
v_mfma_f32_16x16x32_bf16 v[28:31], a[188:191], v[208:211], v[28:31]
v_exp_f32 v204, v204
v_mfma_f32_16x16x32_bf16 v[192:195], a[128:131], a[64:67], 0
buffer_store_dwordx4 v[244:247], v231, s[28:31], 0 offen offset:1024 nt
v_add_f32 v219, v219, v204
v_mov_b32 v230, v218
v_mfma_f32_16x16x32_bf16 v[192:195], a[132:135], a[68:71], v[192:195]
v_exp_f32 v205, v205
v_mfma_f32_16x16x32_bf16 v[192:195], a[136:139], a[72:75], v[192:195]
v_cvt_pk_bf16_f32 v214, v204, v205
v_add_f32 v219, v219, v201
v_add_f32 v219, v219, v205
v_permlane16_swap_b32 v218, v230
v_mfma_f32_16x16x32_bf16 v[192:195], a[140:143], a[76:79], v[192:195]
v_exp_f32 v206, v206
v_mfma_f32_16x16x32_bf16 v[196:199], a[144:147], a[64:67], 0
buffer_store_dwordx4 v[248:251], v231, s[28:31], 0 offen offset:2048 nt
v_add_f32 v219, v219, v206
v_add_f32 v218, v218, v230
v_mfma_f32_16x16x32_bf16 v[196:199], a[148:151], a[68:71], v[196:199]
v_exp_f32 v207, v207
v_mfma_f32_16x16x32_bf16 v[196:199], a[152:155], a[72:75], v[196:199]
buffer_store_dwordx4 v[252:255], v231, s[28:31], 0 offen offset:3072 nt
v_cvt_pk_bf16_f32 v215, v206, v207
v_rcp_f32 v228, v218
v_mfma_f32_16x16x32_bf16 v[196:199], a[156:159], a[76:79], v[196:199]
v_exp_f32 v192, v192
v_add_f32 v219, v219, v207
v_pk_mul_f32 v[0:1], v[0:1], v[228:229] op_sel_hi:[1,0]
v_pk_mul_f32 v[2:3], v[2:3], v[228:229] op_sel_hi:[1,0]
v_cvt_pk_bf16_f32 v0, v0, v1
v_cvt_pk_bf16_f32 v1, v2, v3
ds_write_b64 v226, v[0:1] offset:0
v_pk_mul_f32 v[4:5], v[4:5], v[228:229] op_sel_hi:[1,0]
v_pk_mul_f32 v[6:7], v[6:7], v[228:229] op_sel_hi:[1,0]
v_cvt_pk_bf16_f32 v4, v4, v5
v_cvt_pk_bf16_f32 v5, v6, v7
ds_write_b64 v226, v[4:5] offset:32
v_pk_mul_f32 v[8:9], v[8:9], v[228:229] op_sel_hi:[1,0]
v_pk_mul_f32 v[10:11], v[10:11], v[228:229] op_sel_hi:[1,0]
v_cvt_pk_bf16_f32 v8, v8, v9
v_cvt_pk_bf16_f32 v9, v10, v11
ds_write_b64 v226, v[8:9] offset:64
v_pk_mul_f32 v[12:13], v[12:13], v[228:229] op_sel_hi:[1,0]
v_pk_mul_f32 v[14:15], v[14:15], v[228:229] op_sel_hi:[1,0]
v_cvt_pk_bf16_f32 v12, v12, v13
v_cvt_pk_bf16_f32 v13, v14, v15
ds_write_b64 v226, v[12:13] offset:96
v_pk_mul_f32 v[16:17], v[16:17], v[228:229] op_sel_hi:[1,0]
v_pk_mul_f32 v[18:19], v[18:19], v[228:229] op_sel_hi:[1,0]
v_cvt_pk_bf16_f32 v16, v16, v17
v_cvt_pk_bf16_f32 v17, v18, v19
ds_write_b64 v226, v[16:17] offset:128
v_pk_mul_f32 v[20:21], v[20:21], v[228:229] op_sel_hi:[1,0]
v_pk_mul_f32 v[22:23], v[22:23], v[228:229] op_sel_hi:[1,0]
v_cvt_pk_bf16_f32 v20, v20, v21
v_cvt_pk_bf16_f32 v21, v22, v23
ds_write_b64 v226, v[20:21] offset:160
v_pk_mul_f32 v[24:25], v[24:25], v[228:229] op_sel_hi:[1,0]
v_pk_mul_f32 v[26:27], v[26:27], v[228:229] op_sel_hi:[1,0]
v_cvt_pk_bf16_f32 v24, v24, v25
v_cvt_pk_bf16_f32 v25, v26, v27
ds_write_b64 v226, v[24:25] offset:192
v_pk_mul_f32 v[28:29], v[28:29], v[228:229] op_sel_hi:[1,0]
v_pk_mul_f32 v[30:31], v[30:31], v[228:229] op_sel_hi:[1,0]
v_cvt_pk_bf16_f32 v28, v28, v29
v_cvt_pk_bf16_f32 v29, v30, v31
ds_write_b64 v226, v[28:29] offset:224
ds_read_b128 v[240:243], v227 offset:0
ds_read_b128 v[244:247], v227 offset:1088
ds_read_b128 v[248:251], v227 offset:2176
ds_read_b128 v[252:255], v227 offset:3264
v_mfma_f32_16x16x32_bf16 v[32:35], a[160:163], v[212:215], v[32:35]
v_add_f32 v219, v219, v202
v_add_f32 v219, v219, v203
v_mfma_f32_16x16x32_bf16 v[36:39], a[164:167], v[212:215], v[36:39]
v_exp_f32 v193, v193
v_mfma_f32_16x16x32_bf16 v[40:43], a[168:171], v[212:215], v[40:43]
v_cvt_pk_bf16_f32 v208, v192, v193
v_add_u32 v231, 8192, v229
v_mov_b32 v230, v219
v_mfma_f32_16x16x32_bf16 v[44:47], a[172:175], v[212:215], v[44:47]
s_waitcnt lgkmcnt(0)
v_exp_f32 v194, v194
v_mfma_f32_16x16x32_bf16 v[48:51], a[176:179], v[212:215], v[48:51]
buffer_store_dwordx4 v[240:243], v231, s[28:31], 0 offen offset:0 nt
v_permlane32_swap_b32 v219, v230
v_mfma_f32_16x16x32_bf16 v[52:55], a[180:183], v[212:215], v[52:55]
v_exp_f32 v195, v195
v_mfma_f32_16x16x32_bf16 v[56:59], a[184:187], v[212:215], v[56:59]
v_cvt_pk_bf16_f32 v209, v194, v195
v_add_f32 v220, v220, v192
v_add_f32 v219, v219, v230
v_mfma_f32_16x16x32_bf16 v[60:63], a[188:191], v[212:215], v[60:63]
v_exp_f32 v196, v196
v_mfma_f32_16x16x32_bf16 v[200:203], a[128:131], a[80:83], 0
buffer_store_dwordx4 v[244:247], v231, s[28:31], 0 offen offset:1024 nt
v_mov_b32 v230, v219
v_mfma_f32_16x16x32_bf16 v[200:203], a[132:135], a[84:87], v[200:203]
v_exp_f32 v197, v197
v_mfma_f32_16x16x32_bf16 v[200:203], a[136:139], a[88:91], v[200:203]
v_cvt_pk_bf16_f32 v210, v196, v197
v_add_f32 v220, v220, v193
v_permlane16_swap_b32 v219, v230
v_mfma_f32_16x16x32_bf16 v[200:203], a[140:143], a[92:95], v[200:203]
v_exp_f32 v198, v198
v_mfma_f32_16x16x32_bf16 v[204:207], a[144:147], a[80:83], 0
buffer_store_dwordx4 v[248:251], v231, s[28:31], 0 offen offset:2048 nt
v_add_f32 v220, v220, v198
v_add_f32 v219, v219, v230
v_mfma_f32_16x16x32_bf16 v[204:207], a[148:151], a[84:87], v[204:207]
v_exp_f32 v199, v199
v_mfma_f32_16x16x32_bf16 v[204:207], a[152:155], a[88:91], v[204:207]
buffer_store_dwordx4 v[252:255], v231, s[28:31], 0 offen offset:3072 nt
v_cvt_pk_bf16_f32 v211, v198, v199
v_rcp_f32 v228, v219
v_mfma_f32_16x16x32_bf16 v[204:207], a[156:159], a[92:95], v[204:207]
v_exp_f32 v200, v200
v_add_f32 v220, v220, v199
v_pk_mul_f32 v[32:33], v[32:33], v[228:229] op_sel_hi:[1,0]
v_pk_mul_f32 v[34:35], v[34:35], v[228:229] op_sel_hi:[1,0]
v_cvt_pk_bf16_f32 v32, v32, v33
v_cvt_pk_bf16_f32 v33, v34, v35
ds_write_b64 v226, v[32:33] offset:0
v_pk_mul_f32 v[36:37], v[36:37], v[228:229] op_sel_hi:[1,0]
v_pk_mul_f32 v[38:39], v[38:39], v[228:229] op_sel_hi:[1,0]
v_cvt_pk_bf16_f32 v36, v36, v37
v_cvt_pk_bf16_f32 v37, v38, v39
ds_write_b64 v226, v[36:37] offset:32
v_pk_mul_f32 v[40:41], v[40:41], v[228:229] op_sel_hi:[1,0]
v_pk_mul_f32 v[42:43], v[42:43], v[228:229] op_sel_hi:[1,0]
v_cvt_pk_bf16_f32 v40, v40, v41
v_cvt_pk_bf16_f32 v41, v42, v43
ds_write_b64 v226, v[40:41] offset:64
v_pk_mul_f32 v[44:45], v[44:45], v[228:229] op_sel_hi:[1,0]
v_pk_mul_f32 v[46:47], v[46:47], v[228:229] op_sel_hi:[1,0]
v_cvt_pk_bf16_f32 v44, v44, v45
v_cvt_pk_bf16_f32 v45, v46, v47
ds_write_b64 v226, v[44:45] offset:96
v_pk_mul_f32 v[48:49], v[48:49], v[228:229] op_sel_hi:[1,0]
v_pk_mul_f32 v[50:51], v[50:51], v[228:229] op_sel_hi:[1,0]
v_cvt_pk_bf16_f32 v48, v48, v49
v_cvt_pk_bf16_f32 v49, v50, v51
ds_write_b64 v226, v[48:49] offset:128
v_pk_mul_f32 v[52:53], v[52:53], v[228:229] op_sel_hi:[1,0]
v_pk_mul_f32 v[54:55], v[54:55], v[228:229] op_sel_hi:[1,0]
v_cvt_pk_bf16_f32 v52, v52, v53
v_cvt_pk_bf16_f32 v53, v54, v55
ds_write_b64 v226, v[52:53] offset:160
v_pk_mul_f32 v[56:57], v[56:57], v[228:229] op_sel_hi:[1,0]
v_pk_mul_f32 v[58:59], v[58:59], v[228:229] op_sel_hi:[1,0]
v_cvt_pk_bf16_f32 v56, v56, v57
v_cvt_pk_bf16_f32 v57, v58, v59
ds_write_b64 v226, v[56:57] offset:192
v_pk_mul_f32 v[60:61], v[60:61], v[228:229] op_sel_hi:[1,0]
v_pk_mul_f32 v[62:63], v[62:63], v[228:229] op_sel_hi:[1,0]
v_cvt_pk_bf16_f32 v60, v60, v61
v_cvt_pk_bf16_f32 v61, v62, v63
ds_write_b64 v226, v[60:61] offset:224
ds_read_b128 v[240:243], v227 offset:0
ds_read_b128 v[244:247], v227 offset:1088
ds_read_b128 v[248:251], v227 offset:2176
ds_read_b128 v[252:255], v227 offset:3264
v_mfma_f32_16x16x32_bf16 v[64:67], a[160:163], v[208:211], v[64:67]
v_add_f32 v220, v220, v194
v_add_f32 v220, v220, v195
v_mfma_f32_16x16x32_bf16 v[68:71], a[164:167], v[208:211], v[68:71]
v_exp_f32 v201, v201
v_mfma_f32_16x16x32_bf16 v[72:75], a[168:171], v[208:211], v[72:75]
v_cvt_pk_bf16_f32 v212, v200, v201
v_add_u32 v231, 12288, v229
v_mfma_f32_16x16x32_bf16 v[76:79], a[172:175], v[208:211], v[76:79]
s_waitcnt lgkmcnt(0)
v_exp_f32 v202, v202
v_mfma_f32_16x16x32_bf16 v[80:83], a[176:179], v[208:211], v[80:83]
buffer_store_dwordx4 v[240:243], v231, s[28:31], 0 offen offset:0 nt
v_mfma_f32_16x16x32_bf16 v[84:87], a[180:183], v[208:211], v[84:87]
v_exp_f32 v203, v203
v_mfma_f32_16x16x32_bf16 v[88:91], a[184:187], v[208:211], v[88:91]
v_cvt_pk_bf16_f32 v213, v202, v203
v_add_f32 v220, v220, v196
v_mfma_f32_16x16x32_bf16 v[92:95], a[188:191], v[208:211], v[92:95]
v_exp_f32 v204, v204
v_mfma_f32_16x16x32_bf16 v[192:195], a[128:131], a[96:99], 0
buffer_store_dwordx4 v[244:247], v231, s[28:31], 0 offen offset:1024 nt
v_mfma_f32_16x16x32_bf16 v[192:195], a[132:135], a[100:103], v[192:195]
v_exp_f32 v205, v205
v_mfma_f32_16x16x32_bf16 v[192:195], a[136:139], a[104:107], v[192:195]
v_cvt_pk_bf16_f32 v214, v204, v205
v_add_f32 v220, v220, v197
v_mfma_f32_16x16x32_bf16 v[192:195], a[140:143], a[108:111], v[192:195]
v_exp_f32 v206, v206
v_mfma_f32_16x16x32_bf16 v[196:199], a[144:147], a[96:99], 0
buffer_store_dwordx4 v[248:251], v231, s[28:31], 0 offen offset:2048 nt
v_mfma_f32_16x16x32_bf16 v[196:199], a[148:151], a[100:103], v[196:199]
v_exp_f32 v207, v207
v_mfma_f32_16x16x32_bf16 v[196:199], a[152:155], a[104:107], v[196:199]
buffer_store_dwordx4 v[252:255], v231, s[28:31], 0 offen offset:3072 nt
v_cvt_pk_bf16_f32 v215, v206, v207
v_mfma_f32_16x16x32_bf16 v[196:199], a[156:159], a[108:111], v[196:199]
v_exp_f32 v192, v192
v_add_f32 v221, v221, v207
v_mfma_f32_16x16x32_bf16 v[96:99], a[160:163], v[212:215], v[96:99]
v_add_f32 v221, v221, v200
v_add_f32 v221, v221, v201
v_mfma_f32_16x16x32_bf16 v[100:103], a[164:167], v[212:215], v[100:103]
v_exp_f32 v193, v193
v_mfma_f32_16x16x32_bf16 v[104:107], a[168:171], v[212:215], v[104:107]
v_cvt_pk_bf16_f32 v208, v192, v193
v_add_f32 v221, v221, v202
v_mfma_f32_16x16x32_bf16 v[108:111], a[172:175], v[212:215], v[108:111]
v_exp_f32 v194, v194
v_mfma_f32_16x16x32_bf16 v[112:115], a[176:179], v[212:215], v[112:115]
v_add_f32 v221, v221, v203
v_add_f32 v221, v221, v204
v_mfma_f32_16x16x32_bf16 v[116:119], a[180:183], v[212:215], v[116:119]
v_exp_f32 v195, v195
v_mfma_f32_16x16x32_bf16 v[120:123], a[184:187], v[212:215], v[120:123]
v_cvt_pk_bf16_f32 v209, v194, v195
v_add_f32 v221, v221, v205
v_add_f32 v222, v222, v195
v_mfma_f32_16x16x32_bf16 v[124:127], a[188:191], v[212:215], v[124:127]
v_exp_f32 v196, v196
v_mfma_f32_16x16x32_bf16 v[200:203], a[128:131], a[112:115], 0
ds_read_b128 a[128:131], v224 offset:0
v_add_f32 v221, v221, v206
v_mfma_f32_16x16x32_bf16 v[200:203], a[132:135], a[116:119], v[200:203]
v_exp_f32 v197, v197
v_mfma_f32_16x16x32_bf16 v[200:203], a[136:139], a[120:123], v[200:203]
ds_read_b128 a[132:135], v224 offset:64
v_cvt_pk_bf16_f32 v210, v196, v197
v_mfma_f32_16x16x32_bf16 v[200:203], a[140:143], a[124:127], v[200:203]
v_exp_f32 v198, v198
v_mfma_f32_16x16x32_bf16 v[204:207], a[144:147], a[112:115], 0
ds_read_b128 a[136:139], v224 offset:128
v_add_f32 v222, v222, v192
v_mfma_f32_16x16x32_bf16 v[204:207], a[148:151], a[116:119], v[204:207]
v_exp_f32 v199, v199
v_mfma_f32_16x16x32_bf16 v[204:207], a[152:155], a[120:123], v[204:207]
ds_read_b128 a[140:143], v224 offset:192
v_cvt_pk_bf16_f32 v211, v198, v199
v_add_f32 v222, v222, v199
v_mfma_f32_16x16x32_bf16 v[204:207], a[156:159], a[124:127], v[204:207]
v_exp_f32 v200, v200
v_mfma_f32_16x16x32_bf16 v[128:131], a[160:163], v[208:211], v[128:131]
ds_read_b128 a[144:147], v224 offset:4352
v_add_f32 v222, v222, v193
v_mfma_f32_16x16x32_bf16 v[132:135], a[164:167], v[208:211], v[132:135]
v_exp_f32 v201, v201
v_mfma_f32_16x16x32_bf16 v[136:139], a[168:171], v[208:211], v[136:139]
ds_read_b128 a[148:151], v224 offset:4416
v_cvt_pk_bf16_f32 v212, v200, v201
v_mfma_f32_16x16x32_bf16 v[140:143], a[172:175], v[208:211], v[140:143]
v_exp_f32 v202, v202
v_mfma_f32_16x16x32_bf16 v[144:147], a[176:179], v[208:211], v[144:147]
ds_read_b128 a[152:155], v224 offset:4480
v_add_f32 v222, v222, v194
v_mfma_f32_16x16x32_bf16 v[148:151], a[180:183], v[208:211], v[148:151]
s_waitcnt lgkmcnt(3)
v_exp_f32 v203, v203
v_mfma_f32_16x16x32_bf16 v[152:155], a[184:187], v[208:211], v[152:155]
ds_read_b128 a[156:159], v224 offset:4544
v_cvt_pk_bf16_f32 v213, v202, v203
v_mfma_f32_16x16x32_bf16 v[156:159], a[188:191], v[208:211], v[156:159]
v_exp_f32 v204, v204
v_mfma_f32_16x16x32_bf16 v[192:195], a[128:131], a[64:67], 0
v_add_f32 v222, v222, v196
v_add_f32 v222, v222, v197
v_mfma_f32_16x16x32_bf16 v[192:195], a[132:135], a[68:71], v[192:195]
v_exp_f32 v205, v205
v_mfma_f32_16x16x32_bf16 v[192:195], a[136:139], a[72:75], v[192:195]
v_cvt_pk_bf16_f32 v214, v204, v205
v_add_f32 v222, v222, v198
v_mfma_f32_16x16x32_bf16 v[192:195], a[140:143], a[76:79], v[192:195]
s_waitcnt lgkmcnt(1)
v_exp_f32 v206, v206
v_mfma_f32_16x16x32_bf16 v[196:199], a[144:147], a[64:67], 0
v_add_f32 v223, v223, v200
v_add_f32 v223, v223, v201
v_add_f32 v223, v223, v206
v_mfma_f32_16x16x32_bf16 v[196:199], a[148:151], a[68:71], v[196:199]
v_exp_f32 v207, v207
v_mfma_f32_16x16x32_bf16 v[196:199], a[152:155], a[72:75], v[196:199]
s_waitcnt lgkmcnt(0)
v_cvt_pk_bf16_f32 v215, v206, v207
v_add_f32 v223, v223, v202
v_add_f32 v223, v223, v207
v_mfma_f32_16x16x32_bf16 v[196:199], a[156:159], a[76:79], v[196:199]
v_exp_f32 v192, v192
v_mfma_f32_16x16x32_bf16 v[160:163], a[160:163], v[212:215], v[160:163]
ds_read_b64_tr_b16 a[160:161], v225 offset:0
v_add_f32 v223, v223, v203
v_mfma_f32_16x16x32_bf16 v[164:167], a[164:167], v[212:215], v[164:167]
ds_read_b64_tr_b16 a[162:163], v225 offset:512
v_exp_f32 v193, v193
v_mfma_f32_16x16x32_bf16 v[168:171], a[168:171], v[212:215], v[168:171]
ds_read_b64_tr_b16 a[164:165], v225 offset:32
v_cvt_pk_bf16_f32 v208, v192, v193
v_mfma_f32_16x16x32_bf16 v[172:175], a[172:175], v[212:215], v[172:175]
ds_read_b64_tr_b16 a[166:167], v225 offset:544
v_exp_f32 v194, v194
v_mfma_f32_16x16x32_bf16 v[176:179], a[176:179], v[212:215], v[176:179]
ds_read_b64_tr_b16 a[168:169], v225 offset:64
v_add_f32 v223, v223, v204
v_add_f32 v220, v220, v194
v_mfma_f32_16x16x32_bf16 v[180:183], a[180:183], v[212:215], v[180:183]
ds_read_b64_tr_b16 a[170:171], v225 offset:576
v_exp_f32 v195, v195
v_mfma_f32_16x16x32_bf16 v[184:187], a[184:187], v[212:215], v[184:187]
ds_read_b64_tr_b16 a[172:173], v225 offset:96
v_cvt_pk_bf16_f32 v209, v194, v195
v_add_f32 v220, v220, v195
v_mfma_f32_16x16x32_bf16 v[188:191], a[188:191], v[212:215], v[188:191]
v_exp_f32 v196, v196
v_mfma_f32_16x16x32_bf16 v[200:203], a[128:131], a[80:83], 0
ds_read_b64_tr_b16 a[174:175], v225 offset:608
v_add_f32 v223, v223, v205
v_add_f32 v220, v220, v196
v_mfma_f32_16x16x32_bf16 v[200:203], a[132:135], a[84:87], v[200:203]
ds_read_b64_tr_b16 a[176:177], v225 offset:128
v_exp_f32 v197, v197
v_mfma_f32_16x16x32_bf16 v[200:203], a[136:139], a[88:91], v[200:203]
ds_read_b64_tr_b16 a[178:179], v225 offset:640
v_cvt_pk_bf16_f32 v210, v196, v197
v_add_f32 v220, v220, v197
v_mfma_f32_16x16x32_bf16 v[200:203], a[140:143], a[92:95], v[200:203]
ds_read_b64_tr_b16 a[180:181], v225 offset:160
v_exp_f32 v198, v198
v_mfma_f32_16x16x32_bf16 v[204:207], a[144:147], a[80:83], 0
ds_read_b64_tr_b16 a[182:183], v225 offset:672
v_add_f32 v220, v220, v192
v_add_f32 v220, v220, v198
v_mfma_f32_16x16x32_bf16 v[204:207], a[148:151], a[84:87], v[204:207]
v_exp_f32 v199, v199
v_mfma_f32_16x16x32_bf16 v[204:207], a[152:155], a[88:91], v[204:207]
ds_read_b64_tr_b16 a[184:185], v225 offset:192
v_cvt_pk_bf16_f32 v211, v198, v199
v_add_f32 v220, v220, v199
v_mfma_f32_16x16x32_bf16 v[204:207], a[156:159], a[92:95], v[204:207]
s_waitcnt lgkmcnt(7)
ds_read_b64_tr_b16 a[186:187], v225 offset:704
v_exp_f32 v200, v200
v_mfma_f32_16x16x32_bf16 v[64:67], a[160:163], v[208:211], v[64:67]
ds_read_b64_tr_b16 a[188:189], v225 offset:224
v_add_f32 v220, v220, v193
v_mfma_f32_16x16x32_bf16 v[68:71], a[164:167], v[208:211], v[68:71]
v_exp_f32 v201, v201
v_mfma_f32_16x16x32_bf16 v[72:75], a[168:171], v[208:211], v[72:75]
s_waitcnt lgkmcnt(5)
ds_read_b64_tr_b16 a[190:191], v225 offset:736
v_cvt_pk_bf16_f32 v212, v200, v201
v_mov_b32 v230, v220
v_mfma_f32_16x16x32_bf16 v[76:79], a[172:175], v[208:211], v[76:79]
v_exp_f32 v202, v202
v_mfma_f32_16x16x32_bf16 v[80:83], a[176:179], v[208:211], v[80:83]
s_waitcnt lgkmcnt(4)
v_add_f32 v221, v221, v200
v_add_f32 v221, v221, v201
v_permlane32_swap_b32 v220, v230
v_mfma_f32_16x16x32_bf16 v[84:87], a[180:183], v[208:211], v[84:87]
s_waitcnt lgkmcnt(2)
v_exp_f32 v203, v203
v_mfma_f32_16x16x32_bf16 v[88:91], a[184:187], v[208:211], v[88:91]
s_waitcnt lgkmcnt(0)
v_cvt_pk_bf16_f32 v213, v202, v203
v_add_f32 v221, v221, v202
v_add_f32 v220, v220, v230
v_mfma_f32_16x16x32_bf16 v[92:95], a[188:191], v[208:211], v[92:95]
v_exp_f32 v204, v204
v_mfma_f32_16x16x32_bf16 v[192:195], a[128:131], a[96:99], 0
v_add_f32 v221, v221, v203
v_add_f32 v221, v221, v204
v_mov_b32 v230, v220
v_mfma_f32_16x16x32_bf16 v[192:195], a[132:135], a[100:103], v[192:195]
v_exp_f32 v205, v205
v_mfma_f32_16x16x32_bf16 v[192:195], a[136:139], a[104:107], v[192:195]
v_cvt_pk_bf16_f32 v214, v204, v205
v_add_f32 v221, v221, v205
v_permlane16_swap_b32 v220, v230
v_mfma_f32_16x16x32_bf16 v[192:195], a[140:143], a[108:111], v[192:195]
v_exp_f32 v206, v206
v_mfma_f32_16x16x32_bf16 v[196:199], a[144:147], a[96:99], 0
v_add_f32 v221, v221, v206
v_add_f32 v220, v220, v230
v_mfma_f32_16x16x32_bf16 v[196:199], a[148:151], a[100:103], v[196:199]
v_exp_f32 v207, v207
v_mfma_f32_16x16x32_bf16 v[196:199], a[152:155], a[104:107], v[196:199]
v_cvt_pk_bf16_f32 v215, v206, v207
v_add_f32 v221, v221, v207
v_rcp_f32 v228, v220
v_mfma_f32_16x16x32_bf16 v[196:199], a[156:159], a[108:111], v[196:199]
v_exp_f32 v192, v192
v_pk_mul_f32 v[64:65], v[64:65], v[228:229] op_sel_hi:[1,0]
v_pk_mul_f32 v[66:67], v[66:67], v[228:229] op_sel_hi:[1,0]
v_cvt_pk_bf16_f32 v64, v64, v65
v_cvt_pk_bf16_f32 v65, v66, v67
ds_write_b64 v226, v[64:65] offset:0
v_pk_mul_f32 v[68:69], v[68:69], v[228:229] op_sel_hi:[1,0]
v_pk_mul_f32 v[70:71], v[70:71], v[228:229] op_sel_hi:[1,0]
v_cvt_pk_bf16_f32 v68, v68, v69
v_cvt_pk_bf16_f32 v69, v70, v71
ds_write_b64 v226, v[68:69] offset:32
v_pk_mul_f32 v[72:73], v[72:73], v[228:229] op_sel_hi:[1,0]
v_pk_mul_f32 v[74:75], v[74:75], v[228:229] op_sel_hi:[1,0]
v_cvt_pk_bf16_f32 v72, v72, v73
v_cvt_pk_bf16_f32 v73, v74, v75
ds_write_b64 v226, v[72:73] offset:64
v_pk_mul_f32 v[76:77], v[76:77], v[228:229] op_sel_hi:[1,0]
v_pk_mul_f32 v[78:79], v[78:79], v[228:229] op_sel_hi:[1,0]
v_cvt_pk_bf16_f32 v76, v76, v77
v_cvt_pk_bf16_f32 v77, v78, v79
ds_write_b64 v226, v[76:77] offset:96
v_pk_mul_f32 v[80:81], v[80:81], v[228:229] op_sel_hi:[1,0]
v_pk_mul_f32 v[82:83], v[82:83], v[228:229] op_sel_hi:[1,0]
v_cvt_pk_bf16_f32 v80, v80, v81
v_cvt_pk_bf16_f32 v81, v82, v83
ds_write_b64 v226, v[80:81] offset:128
v_pk_mul_f32 v[84:85], v[84:85], v[228:229] op_sel_hi:[1,0]
v_pk_mul_f32 v[86:87], v[86:87], v[228:229] op_sel_hi:[1,0]
v_cvt_pk_bf16_f32 v84, v84, v85
v_cvt_pk_bf16_f32 v85, v86, v87
ds_write_b64 v226, v[84:85] offset:160
v_pk_mul_f32 v[88:89], v[88:89], v[228:229] op_sel_hi:[1,0]
v_pk_mul_f32 v[90:91], v[90:91], v[228:229] op_sel_hi:[1,0]
v_cvt_pk_bf16_f32 v88, v88, v89
v_cvt_pk_bf16_f32 v89, v90, v91
ds_write_b64 v226, v[88:89] offset:192
v_pk_mul_f32 v[92:93], v[92:93], v[228:229] op_sel_hi:[1,0]
v_pk_mul_f32 v[94:95], v[94:95], v[228:229] op_sel_hi:[1,0]
v_cvt_pk_bf16_f32 v92, v92, v93
v_cvt_pk_bf16_f32 v93, v94, v95
ds_write_b64 v226, v[92:93] offset:224
ds_read_b128 v[240:243], v227 offset:0
ds_read_b128 v[244:247], v227 offset:1088
ds_read_b128 v[248:251], v227 offset:2176
ds_read_b128 v[252:255], v227 offset:3264
v_mfma_f32_16x16x32_bf16 v[96:99], a[160:163], v[212:215], v[96:99]
v_add_f32 v222, v222, v192
v_mfma_f32_16x16x32_bf16 v[100:103], a[164:167], v[212:215], v[100:103]
v_exp_f32 v193, v193
v_mfma_f32_16x16x32_bf16 v[104:107], a[168:171], v[212:215], v[104:107]
v_cvt_pk_bf16_f32 v208, v192, v193
v_add_u32 v231, 16384, v229
v_mov_b32 v230, v221
v_mfma_f32_16x16x32_bf16 v[108:111], a[172:175], v[212:215], v[108:111]
s_waitcnt lgkmcnt(0)
v_exp_f32 v194, v194
v_mfma_f32_16x16x32_bf16 v[112:115], a[176:179], v[212:215], v[112:115]
buffer_store_dwordx4 v[240:243], v231, s[28:31], 0 offen offset:0 nt
v_permlane32_swap_b32 v221, v230
v_mfma_f32_16x16x32_bf16 v[116:119], a[180:183], v[212:215], v[116:119]
v_exp_f32 v195, v195
v_mfma_f32_16x16x32_bf16 v[120:123], a[184:187], v[212:215], v[120:123]
v_cvt_pk_bf16_f32 v209, v194, v195
v_add_f32 v222, v222, v193
v_add_f32 v221, v221, v230
v_mfma_f32_16x16x32_bf16 v[124:127], a[188:191], v[212:215], v[124:127]
v_exp_f32 v196, v196
v_mfma_f32_16x16x32_bf16 v[200:203], a[128:131], a[112:115], 0
buffer_store_dwordx4 v[244:247], v231, s[28:31], 0 offen offset:1024 nt
v_mov_b32 v230, v221
v_mfma_f32_16x16x32_bf16 v[200:203], a[132:135], a[116:119], v[200:203]
v_exp_f32 v197, v197
v_mfma_f32_16x16x32_bf16 v[200:203], a[136:139], a[120:123], v[200:203]
v_cvt_pk_bf16_f32 v210, v196, v197
v_add_f32 v222, v222, v194
v_add_f32 v222, v222, v197
v_permlane16_swap_b32 v221, v230
v_mfma_f32_16x16x32_bf16 v[200:203], a[140:143], a[124:127], v[200:203]
v_exp_f32 v198, v198
v_mfma_f32_16x16x32_bf16 v[204:207], a[144:147], a[112:115], 0
buffer_store_dwordx4 v[248:251], v231, s[28:31], 0 offen offset:2048 nt
v_add_f32 v222, v222, v198
v_add_f32 v221, v221, v230
v_mfma_f32_16x16x32_bf16 v[204:207], a[148:151], a[116:119], v[204:207]
v_exp_f32 v199, v199
v_mfma_f32_16x16x32_bf16 v[204:207], a[152:155], a[120:123], v[204:207]
buffer_store_dwordx4 v[252:255], v231, s[28:31], 0 offen offset:3072 nt
v_cvt_pk_bf16_f32 v211, v198, v199
v_rcp_f32 v228, v221
v_mfma_f32_16x16x32_bf16 v[204:207], a[156:159], a[124:127], v[204:207]
v_exp_f32 v200, v200
v_add_f32 v222, v222, v199
v_pk_mul_f32 v[96:97], v[96:97], v[228:229] op_sel_hi:[1,0]
v_pk_mul_f32 v[98:99], v[98:99], v[228:229] op_sel_hi:[1,0]
v_cvt_pk_bf16_f32 v96, v96, v97
v_cvt_pk_bf16_f32 v97, v98, v99
ds_write_b64 v226, v[96:97] offset:0
v_pk_mul_f32 v[100:101], v[100:101], v[228:229] op_sel_hi:[1,0]
v_pk_mul_f32 v[102:103], v[102:103], v[228:229] op_sel_hi:[1,0]
v_cvt_pk_bf16_f32 v100, v100, v101
v_cvt_pk_bf16_f32 v101, v102, v103
ds_write_b64 v226, v[100:101] offset:32
v_pk_mul_f32 v[104:105], v[104:105], v[228:229] op_sel_hi:[1,0]
v_pk_mul_f32 v[106:107], v[106:107], v[228:229] op_sel_hi:[1,0]
v_cvt_pk_bf16_f32 v104, v104, v105
v_cvt_pk_bf16_f32 v105, v106, v107
ds_write_b64 v226, v[104:105] offset:64
v_pk_mul_f32 v[108:109], v[108:109], v[228:229] op_sel_hi:[1,0]
v_pk_mul_f32 v[110:111], v[110:111], v[228:229] op_sel_hi:[1,0]
v_cvt_pk_bf16_f32 v108, v108, v109
v_cvt_pk_bf16_f32 v109, v110, v111
ds_write_b64 v226, v[108:109] offset:96
v_pk_mul_f32 v[112:113], v[112:113], v[228:229] op_sel_hi:[1,0]
v_pk_mul_f32 v[114:115], v[114:115], v[228:229] op_sel_hi:[1,0]
v_cvt_pk_bf16_f32 v112, v112, v113
v_cvt_pk_bf16_f32 v113, v114, v115
ds_write_b64 v226, v[112:113] offset:128
v_pk_mul_f32 v[116:117], v[116:117], v[228:229] op_sel_hi:[1,0]
v_pk_mul_f32 v[118:119], v[118:119], v[228:229] op_sel_hi:[1,0]
v_cvt_pk_bf16_f32 v116, v116, v117
v_cvt_pk_bf16_f32 v117, v118, v119
ds_write_b64 v226, v[116:117] offset:160
v_pk_mul_f32 v[120:121], v[120:121], v[228:229] op_sel_hi:[1,0]
v_pk_mul_f32 v[122:123], v[122:123], v[228:229] op_sel_hi:[1,0]
v_cvt_pk_bf16_f32 v120, v120, v121
v_cvt_pk_bf16_f32 v121, v122, v123
ds_write_b64 v226, v[120:121] offset:192
v_pk_mul_f32 v[124:125], v[124:125], v[228:229] op_sel_hi:[1,0]
v_pk_mul_f32 v[126:127], v[126:127], v[228:229] op_sel_hi:[1,0]
v_cvt_pk_bf16_f32 v124, v124, v125
v_cvt_pk_bf16_f32 v125, v126, v127
ds_write_b64 v226, v[124:125] offset:224
ds_read_b128 v[240:243], v227 offset:0
ds_read_b128 v[244:247], v227 offset:1088
ds_read_b128 v[248:251], v227 offset:2176
ds_read_b128 v[252:255], v227 offset:3264
v_mfma_f32_16x16x32_bf16 v[128:131], a[160:163], v[208:211], v[128:131]
v_add_f32 v222, v222, v195
v_add_f32 v222, v222, v196
v_mfma_f32_16x16x32_bf16 v[132:135], a[164:167], v[208:211], v[132:135]
v_exp_f32 v201, v201
v_mfma_f32_16x16x32_bf16 v[136:139], a[168:171], v[208:211], v[136:139]
v_cvt_pk_bf16_f32 v212, v200, v201
v_add_u32 v231, 20480, v229
v_mov_b32 v230, v222
v_mfma_f32_16x16x32_bf16 v[140:143], a[172:175], v[208:211], v[140:143]
s_waitcnt lgkmcnt(0)
v_exp_f32 v202, v202
v_mfma_f32_16x16x32_bf16 v[144:147], a[176:179], v[208:211], v[144:147]
buffer_store_dwordx4 v[240:243], v231, s[28:31], 0 offen offset:0 nt
v_permlane32_swap_b32 v222, v230
v_mfma_f32_16x16x32_bf16 v[148:151], a[180:183], v[208:211], v[148:151]
v_exp_f32 v203, v203
v_mfma_f32_16x16x32_bf16 v[152:155], a[184:187], v[208:211], v[152:155]
v_cvt_pk_bf16_f32 v213, v202, v203
v_add_f32 v223, v223, v200
v_add_f32 v222, v222, v230
v_mfma_f32_16x16x32_bf16 v[156:159], a[188:191], v[208:211], v[156:159]
v_exp_f32 v204, v204
buffer_store_dwordx4 v[244:247], v231, s[28:31], 0 offen offset:1024 nt
v_mov_b32 v230, v222
v_exp_f32 v205, v205
s_nop 0
v_cvt_pk_bf16_f32 v214, v204, v205
v_add_f32 v223, v223, v201
v_permlane16_swap_b32 v222, v230
v_exp_f32 v206, v206
buffer_store_dwordx4 v[248:251], v231, s[28:31], 0 offen offset:2048 nt
v_add_f32 v222, v222, v230
v_exp_f32 v207, v207
buffer_store_dwordx4 v[252:255], v231, s[28:31], 0 offen offset:3072 nt
v_cvt_pk_bf16_f32 v215, v206, v207
v_rcp_f32 v228, v222
v_add_f32 v223, v223, v202
v_add_f32 v223, v223, v203
v_mfma_f32_16x16x32_bf16 v[160:163], a[160:163], v[212:215], v[160:163]
v_add_f32 v223, v223, v204
v_add_f32 v223, v223, v205
v_mfma_f32_16x16x32_bf16 v[164:167], a[164:167], v[212:215], v[164:167]
v_add_f32 v223, v223, v206
v_add_f32 v223, v223, v207
v_mfma_f32_16x16x32_bf16 v[168:171], a[168:171], v[212:215], v[168:171]
v_mfma_f32_16x16x32_bf16 v[172:175], a[172:175], v[212:215], v[172:175]
v_mfma_f32_16x16x32_bf16 v[176:179], a[176:179], v[212:215], v[176:179]
v_mfma_f32_16x16x32_bf16 v[180:183], a[180:183], v[212:215], v[180:183]
v_mfma_f32_16x16x32_bf16 v[184:187], a[184:187], v[212:215], v[184:187]
v_mfma_f32_16x16x32_bf16 v[188:191], a[188:191], v[212:215], v[188:191]
v_pk_mul_f32 v[128:129], v[128:129], v[228:229] op_sel_hi:[1,0]
v_pk_mul_f32 v[130:131], v[130:131], v[228:229] op_sel_hi:[1,0]
v_cvt_pk_bf16_f32 v128, v128, v129
v_cvt_pk_bf16_f32 v129, v130, v131
ds_write_b64 v226, v[128:129] offset:0
v_pk_mul_f32 v[132:133], v[132:133], v[228:229] op_sel_hi:[1,0]
v_pk_mul_f32 v[134:135], v[134:135], v[228:229] op_sel_hi:[1,0]
v_cvt_pk_bf16_f32 v132, v132, v133
v_cvt_pk_bf16_f32 v133, v134, v135
ds_write_b64 v226, v[132:133] offset:32
v_pk_mul_f32 v[136:137], v[136:137], v[228:229] op_sel_hi:[1,0]
v_pk_mul_f32 v[138:139], v[138:139], v[228:229] op_sel_hi:[1,0]
v_cvt_pk_bf16_f32 v136, v136, v137
v_cvt_pk_bf16_f32 v137, v138, v139
ds_write_b64 v226, v[136:137] offset:64
v_pk_mul_f32 v[140:141], v[140:141], v[228:229] op_sel_hi:[1,0]
v_pk_mul_f32 v[142:143], v[142:143], v[228:229] op_sel_hi:[1,0]
v_cvt_pk_bf16_f32 v140, v140, v141
v_cvt_pk_bf16_f32 v141, v142, v143
ds_write_b64 v226, v[140:141] offset:96
v_pk_mul_f32 v[144:145], v[144:145], v[228:229] op_sel_hi:[1,0]
v_pk_mul_f32 v[146:147], v[146:147], v[228:229] op_sel_hi:[1,0]
v_cvt_pk_bf16_f32 v144, v144, v145
v_cvt_pk_bf16_f32 v145, v146, v147
ds_write_b64 v226, v[144:145] offset:128
v_pk_mul_f32 v[148:149], v[148:149], v[228:229] op_sel_hi:[1,0]
v_pk_mul_f32 v[150:151], v[150:151], v[228:229] op_sel_hi:[1,0]
v_cvt_pk_bf16_f32 v148, v148, v149
v_cvt_pk_bf16_f32 v149, v150, v151
ds_write_b64 v226, v[148:149] offset:160
v_pk_mul_f32 v[152:153], v[152:153], v[228:229] op_sel_hi:[1,0]
v_pk_mul_f32 v[154:155], v[154:155], v[228:229] op_sel_hi:[1,0]
v_cvt_pk_bf16_f32 v152, v152, v153
v_cvt_pk_bf16_f32 v153, v154, v155
ds_write_b64 v226, v[152:153] offset:192
v_pk_mul_f32 v[156:157], v[156:157], v[228:229] op_sel_hi:[1,0]
v_pk_mul_f32 v[158:159], v[158:159], v[228:229] op_sel_hi:[1,0]
v_cvt_pk_bf16_f32 v156, v156, v157
v_cvt_pk_bf16_f32 v157, v158, v159
ds_write_b64 v226, v[156:157] offset:224
ds_read_b128 v[240:243], v227 offset:0
ds_read_b128 v[244:247], v227 offset:1088
ds_read_b128 v[248:251], v227 offset:2176
ds_read_b128 v[252:255], v227 offset:3264
v_mov_b32 v230, v223
v_add_u32 v231, 24576, v229
s_waitcnt lgkmcnt(0)
v_permlane32_swap_b32 v223, v230
buffer_store_dwordx4 v[240:243], v231, s[28:31], 0 offen offset:0 nt
v_add_f32 v223, v223, v230
buffer_store_dwordx4 v[244:247], v231, s[28:31], 0 offen offset:1024 nt
v_mov_b32 v230, v223
buffer_store_dwordx4 v[248:251], v231, s[28:31], 0 offen offset:2048 nt
buffer_store_dwordx4 v[252:255], v231, s[28:31], 0 offen offset:3072 nt
v_permlane16_swap_b32 v223, v230
v_add_f32 v223, v223, v230
v_rcp_f32 v228, v223
s_nop 0
v_pk_mul_f32 v[160:161], v[160:161], v[228:229] op_sel_hi:[1,0]
v_pk_mul_f32 v[162:163], v[162:163], v[228:229] op_sel_hi:[1,0]
v_cvt_pk_bf16_f32 v160, v160, v161
v_cvt_pk_bf16_f32 v161, v162, v163
ds_write_b64 v226, v[160:161] offset:0
v_pk_mul_f32 v[164:165], v[164:165], v[228:229] op_sel_hi:[1,0]
v_pk_mul_f32 v[166:167], v[166:167], v[228:229] op_sel_hi:[1,0]
v_cvt_pk_bf16_f32 v164, v164, v165
v_cvt_pk_bf16_f32 v165, v166, v167
ds_write_b64 v226, v[164:165] offset:32
v_pk_mul_f32 v[168:169], v[168:169], v[228:229] op_sel_hi:[1,0]
v_pk_mul_f32 v[170:171], v[170:171], v[228:229] op_sel_hi:[1,0]
v_cvt_pk_bf16_f32 v168, v168, v169
v_cvt_pk_bf16_f32 v169, v170, v171
ds_write_b64 v226, v[168:169] offset:64
v_pk_mul_f32 v[172:173], v[172:173], v[228:229] op_sel_hi:[1,0]
v_pk_mul_f32 v[174:175], v[174:175], v[228:229] op_sel_hi:[1,0]
v_cvt_pk_bf16_f32 v172, v172, v173
v_cvt_pk_bf16_f32 v173, v174, v175
ds_write_b64 v226, v[172:173] offset:96
v_pk_mul_f32 v[176:177], v[176:177], v[228:229] op_sel_hi:[1,0]
v_pk_mul_f32 v[178:179], v[178:179], v[228:229] op_sel_hi:[1,0]
v_cvt_pk_bf16_f32 v176, v176, v177
v_cvt_pk_bf16_f32 v177, v178, v179
ds_write_b64 v226, v[176:177] offset:128
v_pk_mul_f32 v[180:181], v[180:181], v[228:229] op_sel_hi:[1,0]
v_pk_mul_f32 v[182:183], v[182:183], v[228:229] op_sel_hi:[1,0]
v_cvt_pk_bf16_f32 v180, v180, v181
v_cvt_pk_bf16_f32 v181, v182, v183
ds_write_b64 v226, v[180:181] offset:160
v_pk_mul_f32 v[184:185], v[184:185], v[228:229] op_sel_hi:[1,0]
v_pk_mul_f32 v[186:187], v[186:187], v[228:229] op_sel_hi:[1,0]
v_cvt_pk_bf16_f32 v184, v184, v185
v_cvt_pk_bf16_f32 v185, v186, v187
ds_write_b64 v226, v[184:185] offset:192
v_pk_mul_f32 v[188:189], v[188:189], v[228:229] op_sel_hi:[1,0]
v_pk_mul_f32 v[190:191], v[190:191], v[228:229] op_sel_hi:[1,0]
v_cvt_pk_bf16_f32 v188, v188, v189
v_cvt_pk_bf16_f32 v189, v190, v191
ds_write_b64 v226, v[188:189] offset:224
ds_read_b128 v[240:243], v227 offset:0
ds_read_b128 v[244:247], v227 offset:1088
ds_read_b128 v[248:251], v227 offset:2176
ds_read_b128 v[252:255], v227 offset:3264
v_add_u32 v231, 28672, v229
s_waitcnt lgkmcnt(0)
buffer_store_dwordx4 v[240:243], v231, s[28:31], 0 offen offset:0 nt
buffer_store_dwordx4 v[244:247], v231, s[28:31], 0 offen offset:1024 nt
buffer_store_dwordx4 v[248:251], v231, s[28:31], 0 offen offset:2048 nt
buffer_store_dwordx4 v[252:255], v231, s[28:31], 0 offen offset:3072 nt
v_subrev_u32 v230, 0x33800000, v216
v_cmp_le_u32 vcc, 0x18000000, v230
s_nop 1
s_or_b64 s[32:33], s[32:33], vcc
v_subrev_u32 v230, 0x33800000, v217
v_cmp_le_u32 vcc, 0x18000000, v230
s_nop 1
s_or_b64 s[32:33], s[32:33], vcc
v_subrev_u32 v230, 0x33800000, v218
v_cmp_le_u32 vcc, 0x18000000, v230
s_nop 1
s_or_b64 s[32:33], s[32:33], vcc
v_subrev_u32 v230, 0x33800000, v219
v_cmp_le_u32 vcc, 0x18000000, v230
s_nop 1
s_or_b64 s[32:33], s[32:33], vcc
v_subrev_u32 v230, 0x33800000, v220
v_cmp_le_u32 vcc, 0x18000000, v230
s_nop 1
s_or_b64 s[32:33], s[32:33], vcc
v_subrev_u32 v230, 0x33800000, v221
v_cmp_le_u32 vcc, 0x18000000, v230
s_nop 1
s_or_b64 s[32:33], s[32:33], vcc
v_subrev_u32 v230, 0x33800000, v222
v_cmp_le_u32 vcc, 0x18000000, v230
s_nop 1
s_or_b64 s[32:33], s[32:33], vcc
v_subrev_u32 v230, 0x33800000, v223
v_cmp_le_u32 vcc, 0x18000000, v230
s_nop 1
s_or_b64 s[32:33], s[32:33], vcc
L_fastend:
s_cmp_eq_u64 s[32:33], 0
s_cbranch_scc1 L_done
s_waitcnt vmcnt(0) lgkmcnt(0)
s_mov_b32 s22, 131072
s_mov_b32 s26, 131072
v_mbcnt_lo_u32_b32 v1, -1, 0
v_mbcnt_hi_u32_b32 v1, -1, v1
v_and_b32 v2, 63, v1
v_lshrrev_b32 v5, 4, v2
v_and_b32 v6, 15, v2
v_and_b32 v7, 3, v6
v_lshrrev_b32 v3, 2, v6
v_xor_b32 v8, v7, v5
v_and_b32 v9, 12, v6
v_or_b32 v8, v8, v9
v_lshlrev_b32 v9, 8, v5
v_lshl_add_u32 v9, v8, 4, v9
v_mov_b32 v232, v9
v_lshlrev_b32 v12, 11, v5
v_lshl_add_u32 v233, v6, 4, v12
v_xor_b32 v10, v5, v7
v_lshlrev_b32 v10, 4, v10
v_lshl_add_u32 v10, v7, 8, v10
v_mul_u32_u24 v8, 1088, v3
v_add_u32 v224, v8, v10
v_and_b32 v8, 1, v5
v_lshl_add_u32 v8, v8, 2, v3
v_mul_u32_u24 v8, 1056, v8
v_lshrrev_b32 v11, 1, v5
v_lshl_add_u32 v8, v11, 8, v8
v_lshl_add_u32 v8, v7, 3, v8
v_add_u32 v225, 8704, v8
v_add_u32 v224, s47, v224
v_add_u32 v225, s47, v225
s_lshl_b32 s41, s3, 15
v_add_u32 v234, s41, v232
s_add_u32 m0, s47, 0
s_nop 0
buffer_load_dwordx4 v234, s[16:19], 0 offen offset:0 lds
s_add_u32 m0, s47, 64
s_nop 0
buffer_load_dwordx4 v234, s[16:19], 0 offen offset:1024 lds
s_add_u32 m0, s47, 128
s_nop 0
buffer_load_dwordx4 v234, s[16:19], 0 offen offset:2048 lds
s_add_u32 m0, s47, 192
s_nop 0
buffer_load_dwordx4 v234, s[16:19], 0 offen offset:3072 lds
v_add_u32 v234, 4096, v234
s_waitcnt vmcnt(0)
ds_read_b128 a[0:3], v224 offset:0
ds_read_b128 a[4:7], v224 offset:64
ds_read_b128 a[8:11], v224 offset:128
ds_read_b128 a[12:15], v224 offset:192
s_waitcnt lgkmcnt(0)
s_add_u32 m0, s47, 0
s_nop 0
buffer_load_dwordx4 v234, s[16:19], 0 offen offset:0 lds
s_add_u32 m0, s47, 64
s_nop 0
buffer_load_dwordx4 v234, s[16:19], 0 offen offset:1024 lds
s_add_u32 m0, s47, 128
s_nop 0
buffer_load_dwordx4 v234, s[16:19], 0 offen offset:2048 lds
s_add_u32 m0, s47, 192
s_nop 0
buffer_load_dwordx4 v234, s[16:19], 0 offen offset:3072 lds
v_add_u32 v234, 4096, v234
s_waitcnt vmcnt(0)
ds_read_b128 a[16:19], v224 offset:0
ds_read_b128 a[20:23], v224 offset:64
ds_read_b128 a[24:27], v224 offset:128
ds_read_b128 a[28:31], v224 offset:192
s_waitcnt lgkmcnt(0)
s_add_u32 m0, s47, 0
s_nop 0
buffer_load_dwordx4 v234, s[16:19], 0 offen offset:0 lds
s_add_u32 m0, s47, 64
s_nop 0
buffer_load_dwordx4 v234, s[16:19], 0 offen offset:1024 lds
s_add_u32 m0, s47, 128
s_nop 0
buffer_load_dwordx4 v234, s[16:19], 0 offen offset:2048 lds
s_add_u32 m0, s47, 192
s_nop 0
buffer_load_dwordx4 v234, s[16:19], 0 offen offset:3072 lds
v_add_u32 v234, 4096, v234
s_waitcnt vmcnt(0)
ds_read_b128 a[32:35], v224 offset:0
ds_read_b128 a[36:39], v224 offset:64
ds_read_b128 a[40:43], v224 offset:128
ds_read_b128 a[44:47], v224 offset:192
s_waitcnt lgkmcnt(0)
s_add_u32 m0, s47, 0
s_nop 0
buffer_load_dwordx4 v234, s[16:19], 0 offen offset:0 lds
s_add_u32 m0, s47, 64
s_nop 0
buffer_load_dwordx4 v234, s[16:19], 0 offen offset:1024 lds
s_add_u32 m0, s47, 128
s_nop 0
buffer_load_dwordx4 v234, s[16:19], 0 offen offset:2048 lds
s_add_u32 m0, s47, 192
s_nop 0
buffer_load_dwordx4 v234, s[16:19], 0 offen offset:3072 lds
v_add_u32 v234, 4096, v234
s_waitcnt vmcnt(0)
ds_read_b128 a[48:51], v224 offset:0
ds_read_b128 a[52:55], v224 offset:64
ds_read_b128 a[56:59], v224 offset:128
ds_read_b128 a[60:63], v224 offset:192
s_waitcnt lgkmcnt(0)
s_add_u32 m0, s47, 0
s_nop 0
buffer_load_dwordx4 v234, s[16:19], 0 offen offset:0 lds
s_add_u32 m0, s47, 64
s_nop 0
buffer_load_dwordx4 v234, s[16:19], 0 offen offset:1024 lds
s_add_u32 m0, s47, 128
s_nop 0
buffer_load_dwordx4 v234, s[16:19], 0 offen offset:2048 lds
s_add_u32 m0, s47, 192
s_nop 0
buffer_load_dwordx4 v234, s[16:19], 0 offen offset:3072 lds
v_add_u32 v234, 4096, v234
s_waitcnt vmcnt(0)
ds_read_b128 a[64:67], v224 offset:0
ds_read_b128 a[68:71], v224 offset:64
ds_read_b128 a[72:75], v224 offset:128
ds_read_b128 a[76:79], v224 offset:192
s_waitcnt lgkmcnt(0)
s_add_u32 m0, s47, 0
s_nop 0
buffer_load_dwordx4 v234, s[16:19], 0 offen offset:0 lds
s_add_u32 m0, s47, 64
s_nop 0
buffer_load_dwordx4 v234, s[16:19], 0 offen offset:1024 lds
s_add_u32 m0, s47, 128
s_nop 0
buffer_load_dwordx4 v234, s[16:19], 0 offen offset:2048 lds
s_add_u32 m0, s47, 192
s_nop 0
buffer_load_dwordx4 v234, s[16:19], 0 offen offset:3072 lds
v_add_u32 v234, 4096, v234
s_waitcnt vmcnt(0)
ds_read_b128 a[80:83], v224 offset:0
ds_read_b128 a[84:87], v224 offset:64
ds_read_b128 a[88:91], v224 offset:128
ds_read_b128 a[92:95], v224 offset:192
s_waitcnt lgkmcnt(0)
s_add_u32 m0, s47, 0
s_nop 0
buffer_load_dwordx4 v234, s[16:19], 0 offen offset:0 lds
s_add_u32 m0, s47, 64
s_nop 0
buffer_load_dwordx4 v234, s[16:19], 0 offen offset:1024 lds
s_add_u32 m0, s47, 128
s_nop 0
buffer_load_dwordx4 v234, s[16:19], 0 offen offset:2048 lds
s_add_u32 m0, s47, 192
s_nop 0
buffer_load_dwordx4 v234, s[16:19], 0 offen offset:3072 lds
v_add_u32 v234, 4096, v234
s_waitcnt vmcnt(0)
ds_read_b128 a[96:99], v224 offset:0
ds_read_b128 a[100:103], v224 offset:64
ds_read_b128 a[104:107], v224 offset:128
ds_read_b128 a[108:111], v224 offset:192
s_waitcnt lgkmcnt(0)
s_add_u32 m0, s47, 0
s_nop 0
buffer_load_dwordx4 v234, s[16:19], 0 offen offset:0 lds
s_add_u32 m0, s47, 64
s_nop 0
buffer_load_dwordx4 v234, s[16:19], 0 offen offset:1024 lds
s_add_u32 m0, s47, 128
s_nop 0
buffer_load_dwordx4 v234, s[16:19], 0 offen offset:2048 lds
s_add_u32 m0, s47, 192
s_nop 0
buffer_load_dwordx4 v234, s[16:19], 0 offen offset:3072 lds
v_add_u32 v234, 4096, v234
s_waitcnt vmcnt(0)
ds_read_b128 a[112:115], v224 offset:0
ds_read_b128 a[116:119], v224 offset:64
ds_read_b128 a[120:123], v224 offset:128
ds_read_b128 a[124:127], v224 offset:192
s_waitcnt lgkmcnt(0)
v_mov_b32 v240, 0xff800000
v_mov_b32 v241, 0xff800000
v_mov_b32 v242, 0xff800000
v_mov_b32 v243, 0xff800000
v_mov_b32 v244, 0xff800000
v_mov_b32 v245, 0xff800000
v_mov_b32 v246, 0xff800000
v_mov_b32 v247, 0xff800000
s_mov_b32 s35, 0
L_slow1:
s_add_u32 m0, s47, 0
s_add_u32 s41, s35, 0
buffer_load_dwordx4 v232, s[20:23], s41 offen lds
s_add_u32 m0, s47, 1088
s_add_u32 s41, s35, 1024
buffer_load_dwordx4 v232, s[20:23], s41 offen lds
s_add_u32 m0, s47, 2176
s_add_u32 s41, s35, 2048
buffer_load_dwordx4 v232, s[20:23], s41 offen lds
s_add_u32 m0, s47, 3264
s_add_u32 s41, s35, 3072
buffer_load_dwordx4 v232, s[20:23], s41 offen lds
s_add_u32 m0, s47, 4352
s_add_u32 s41, s35, 4096
buffer_load_dwordx4 v232, s[20:23], s41 offen lds
s_add_u32 m0, s47, 5440
s_add_u32 s41, s35, 5120
buffer_load_dwordx4 v232, s[20:23], s41 offen lds
s_add_u32 m0, s47, 6528
s_add_u32 s41, s35, 6144
buffer_load_dwordx4 v232, s[20:23], s41 offen lds
s_add_u32 m0, s47, 7616
s_add_u32 s41, s35, 7168
buffer_load_dwordx4 v232, s[20:23], s41 offen lds
s_waitcnt vmcnt(0)
ds_read_b128 a[128:131], v224 offset:0
ds_read_b128 a[132:135], v224 offset:64
ds_read_b128 a[136:139], v224 offset:128
ds_read_b128 a[140:143], v224 offset:192
ds_read_b128 a[144:147], v224 offset:4352
ds_read_b128 a[148:151], v224 offset:4416
ds_read_b128 a[152:155], v224 offset:4480
ds_read_b128 a[156:159], v224 offset:4544
s_waitcnt lgkmcnt(0)
v_mfma_f32_16x16x32_bf16 v[192:195], a[128:131], a[0:3], 0
v_mfma_f32_16x16x32_bf16 v[192:195], a[132:135], a[4:7], v[192:195]
v_mfma_f32_16x16x32_bf16 v[192:195], a[136:139], a[8:11], v[192:195]
v_mfma_f32_16x16x32_bf16 v[192:195], a[140:143], a[12:15], v[192:195]
v_mfma_f32_16x16x32_bf16 v[196:199], a[144:147], a[0:3], 0
v_mfma_f32_16x16x32_bf16 v[196:199], a[148:151], a[4:7], v[196:199]
v_mfma_f32_16x16x32_bf16 v[196:199], a[152:155], a[8:11], v[196:199]
v_mfma_f32_16x16x32_bf16 v[196:199], a[156:159], a[12:15], v[196:199]
s_nop 3
v_max3_f32 v240, v240, v192, v193
v_max3_f32 v240, v240, v194, v195
s_nop 1
v_max3_f32 v240, v240, v196, v197
v_max3_f32 v240, v240, v198, v199
v_mfma_f32_16x16x32_bf16 v[192:195], a[128:131], a[16:19], 0
v_mfma_f32_16x16x32_bf16 v[192:195], a[132:135], a[20:23], v[192:195]
v_mfma_f32_16x16x32_bf16 v[192:195], a[136:139], a[24:27], v[192:195]
v_mfma_f32_16x16x32_bf16 v[192:195], a[140:143], a[28:31], v[192:195]
v_mfma_f32_16x16x32_bf16 v[196:199], a[144:147], a[16:19], 0
v_mfma_f32_16x16x32_bf16 v[196:199], a[148:151], a[20:23], v[196:199]
v_mfma_f32_16x16x32_bf16 v[196:199], a[152:155], a[24:27], v[196:199]
v_mfma_f32_16x16x32_bf16 v[196:199], a[156:159], a[28:31], v[196:199]
s_nop 3
v_max3_f32 v241, v241, v192, v193
v_max3_f32 v241, v241, v194, v195
s_nop 1
v_max3_f32 v241, v241, v196, v197
v_max3_f32 v241, v241, v198, v199
v_mfma_f32_16x16x32_bf16 v[192:195], a[128:131], a[32:35], 0
v_mfma_f32_16x16x32_bf16 v[192:195], a[132:135], a[36:39], v[192:195]
v_mfma_f32_16x16x32_bf16 v[192:195], a[136:139], a[40:43], v[192:195]
v_mfma_f32_16x16x32_bf16 v[192:195], a[140:143], a[44:47], v[192:195]
v_mfma_f32_16x16x32_bf16 v[196:199], a[144:147], a[32:35], 0
v_mfma_f32_16x16x32_bf16 v[196:199], a[148:151], a[36:39], v[196:199]
v_mfma_f32_16x16x32_bf16 v[196:199], a[152:155], a[40:43], v[196:199]
v_mfma_f32_16x16x32_bf16 v[196:199], a[156:159], a[44:47], v[196:199]
s_nop 3
v_max3_f32 v242, v242, v192, v193
v_max3_f32 v242, v242, v194, v195
s_nop 1
v_max3_f32 v242, v242, v196, v197
v_max3_f32 v242, v242, v198, v199
v_mfma_f32_16x16x32_bf16 v[192:195], a[128:131], a[48:51], 0
v_mfma_f32_16x16x32_bf16 v[192:195], a[132:135], a[52:55], v[192:195]
v_mfma_f32_16x16x32_bf16 v[192:195], a[136:139], a[56:59], v[192:195]
v_mfma_f32_16x16x32_bf16 v[192:195], a[140:143], a[60:63], v[192:195]
v_mfma_f32_16x16x32_bf16 v[196:199], a[144:147], a[48:51], 0
v_mfma_f32_16x16x32_bf16 v[196:199], a[148:151], a[52:55], v[196:199]
v_mfma_f32_16x16x32_bf16 v[196:199], a[152:155], a[56:59], v[196:199]
v_mfma_f32_16x16x32_bf16 v[196:199], a[156:159], a[60:63], v[196:199]
s_nop 3
v_max3_f32 v243, v243, v192, v193
v_max3_f32 v243, v243, v194, v195
s_nop 1
v_max3_f32 v243, v243, v196, v197
v_max3_f32 v243, v243, v198, v199
v_mfma_f32_16x16x32_bf16 v[192:195], a[128:131], a[64:67], 0
v_mfma_f32_16x16x32_bf16 v[192:195], a[132:135], a[68:71], v[192:195]
v_mfma_f32_16x16x32_bf16 v[192:195], a[136:139], a[72:75], v[192:195]
v_mfma_f32_16x16x32_bf16 v[192:195], a[140:143], a[76:79], v[192:195]
v_mfma_f32_16x16x32_bf16 v[196:199], a[144:147], a[64:67], 0
v_mfma_f32_16x16x32_bf16 v[196:199], a[148:151], a[68:71], v[196:199]
v_mfma_f32_16x16x32_bf16 v[196:199], a[152:155], a[72:75], v[196:199]
v_mfma_f32_16x16x32_bf16 v[196:199], a[156:159], a[76:79], v[196:199]
s_nop 3
v_max3_f32 v244, v244, v192, v193
v_max3_f32 v244, v244, v194, v195
s_nop 1
v_max3_f32 v244, v244, v196, v197
v_max3_f32 v244, v244, v198, v199
v_mfma_f32_16x16x32_bf16 v[192:195], a[128:131], a[80:83], 0
v_mfma_f32_16x16x32_bf16 v[192:195], a[132:135], a[84:87], v[192:195]
v_mfma_f32_16x16x32_bf16 v[192:195], a[136:139], a[88:91], v[192:195]
v_mfma_f32_16x16x32_bf16 v[192:195], a[140:143], a[92:95], v[192:195]
v_mfma_f32_16x16x32_bf16 v[196:199], a[144:147], a[80:83], 0
v_mfma_f32_16x16x32_bf16 v[196:199], a[148:151], a[84:87], v[196:199]
v_mfma_f32_16x16x32_bf16 v[196:199], a[152:155], a[88:91], v[196:199]
v_mfma_f32_16x16x32_bf16 v[196:199], a[156:159], a[92:95], v[196:199]
s_nop 3
v_max3_f32 v245, v245, v192, v193
v_max3_f32 v245, v245, v194, v195
s_nop 1
v_max3_f32 v245, v245, v196, v197
v_max3_f32 v245, v245, v198, v199
v_mfma_f32_16x16x32_bf16 v[192:195], a[128:131], a[96:99], 0
v_mfma_f32_16x16x32_bf16 v[192:195], a[132:135], a[100:103], v[192:195]
v_mfma_f32_16x16x32_bf16 v[192:195], a[136:139], a[104:107], v[192:195]
v_mfma_f32_16x16x32_bf16 v[192:195], a[140:143], a[108:111], v[192:195]
v_mfma_f32_16x16x32_bf16 v[196:199], a[144:147], a[96:99], 0
v_mfma_f32_16x16x32_bf16 v[196:199], a[148:151], a[100:103], v[196:199]
v_mfma_f32_16x16x32_bf16 v[196:199], a[152:155], a[104:107], v[196:199]
v_mfma_f32_16x16x32_bf16 v[196:199], a[156:159], a[108:111], v[196:199]
s_nop 3
v_max3_f32 v246, v246, v192, v193
v_max3_f32 v246, v246, v194, v195
s_nop 1
v_max3_f32 v246, v246, v196, v197
v_max3_f32 v246, v246, v198, v199
v_mfma_f32_16x16x32_bf16 v[192:195], a[128:131], a[112:115], 0
v_mfma_f32_16x16x32_bf16 v[192:195], a[132:135], a[116:119], v[192:195]
v_mfma_f32_16x16x32_bf16 v[192:195], a[136:139], a[120:123], v[192:195]
v_mfma_f32_16x16x32_bf16 v[192:195], a[140:143], a[124:127], v[192:195]
v_mfma_f32_16x16x32_bf16 v[196:199], a[144:147], a[112:115], 0
v_mfma_f32_16x16x32_bf16 v[196:199], a[148:151], a[116:119], v[196:199]
v_mfma_f32_16x16x32_bf16 v[196:199], a[152:155], a[120:123], v[196:199]
v_mfma_f32_16x16x32_bf16 v[196:199], a[156:159], a[124:127], v[196:199]
s_nop 3
v_max3_f32 v247, v247, v192, v193
v_max3_f32 v247, v247, v194, v195
s_nop 1
v_max3_f32 v247, v247, v196, v197
v_max3_f32 v247, v247, v198, v199
s_add_u32 s35, s35, 8192
s_cmp_lt_u32 s35, 131072
s_cbranch_scc1 L_slow1
v_mov_b32 v230, v240
s_nop 1
v_permlane32_swap_b32 v240, v230
v_max_f32 v240, v240, v230
v_mov_b32 v230, v240
s_nop 1
v_permlane16_swap_b32 v240, v230
v_max_f32 v240, v240, v230
v_mul_f32 v240, s38, v240
v_mov_b32 v230, v241
s_nop 1
v_permlane32_swap_b32 v241, v230
v_max_f32 v241, v241, v230
v_mov_b32 v230, v241
s_nop 1
v_permlane16_swap_b32 v241, v230
v_max_f32 v241, v241, v230
v_mul_f32 v241, s38, v241
v_mov_b32 v230, v242
s_nop 1
v_permlane32_swap_b32 v242, v230
v_max_f32 v242, v242, v230
v_mov_b32 v230, v242
s_nop 1
v_permlane16_swap_b32 v242, v230
v_max_f32 v242, v242, v230
v_mul_f32 v242, s38, v242
v_mov_b32 v230, v243
s_nop 1
v_permlane32_swap_b32 v243, v230
v_max_f32 v243, v243, v230
v_mov_b32 v230, v243
s_nop 1
v_permlane16_swap_b32 v243, v230
v_max_f32 v243, v243, v230
v_mul_f32 v243, s38, v243
v_mov_b32 v230, v244
s_nop 1
v_permlane32_swap_b32 v244, v230
v_max_f32 v244, v244, v230
v_mov_b32 v230, v244
s_nop 1
v_permlane16_swap_b32 v244, v230
v_max_f32 v244, v244, v230
v_mul_f32 v244, s38, v244
v_mov_b32 v230, v245
s_nop 1
v_permlane32_swap_b32 v245, v230
v_max_f32 v245, v245, v230
v_mov_b32 v230, v245
s_nop 1
v_permlane16_swap_b32 v245, v230
v_max_f32 v245, v245, v230
v_mul_f32 v245, s38, v245
v_mov_b32 v230, v246
s_nop 1
v_permlane32_swap_b32 v246, v230
v_max_f32 v246, v246, v230
v_mov_b32 v230, v246
s_nop 1
v_permlane16_swap_b32 v246, v230
v_max_f32 v246, v246, v230
v_mul_f32 v246, s38, v246
v_mov_b32 v230, v247
s_nop 1
v_permlane32_swap_b32 v247, v230
v_max_f32 v247, v247, v230
v_mov_b32 v230, v247
s_nop 1
v_permlane16_swap_b32 v247, v230
v_max_f32 v247, v247, v230
v_mul_f32 v247, s38, v247
v_mov_b32 v0, 0
v_mov_b32 v1, 0
v_mov_b32 v2, 0
v_mov_b32 v3, 0
v_mov_b32 v4, 0
v_mov_b32 v5, 0
v_mov_b32 v6, 0
v_mov_b32 v7, 0
v_mov_b32 v8, 0
v_mov_b32 v9, 0
v_mov_b32 v10, 0
v_mov_b32 v11, 0
v_mov_b32 v12, 0
v_mov_b32 v13, 0
v_mov_b32 v14, 0
v_mov_b32 v15, 0
v_mov_b32 v16, 0
v_mov_b32 v17, 0
v_mov_b32 v18, 0
v_mov_b32 v19, 0
v_mov_b32 v20, 0
v_mov_b32 v21, 0
v_mov_b32 v22, 0
v_mov_b32 v23, 0
v_mov_b32 v24, 0
v_mov_b32 v25, 0
v_mov_b32 v26, 0
v_mov_b32 v27, 0
v_mov_b32 v28, 0
v_mov_b32 v29, 0
v_mov_b32 v30, 0
v_mov_b32 v31, 0
v_mov_b32 v32, 0
v_mov_b32 v33, 0
v_mov_b32 v34, 0
v_mov_b32 v35, 0
v_mov_b32 v36, 0
v_mov_b32 v37, 0
v_mov_b32 v38, 0
v_mov_b32 v39, 0
v_mov_b32 v40, 0
v_mov_b32 v41, 0
v_mov_b32 v42, 0
v_mov_b32 v43, 0
v_mov_b32 v44, 0
v_mov_b32 v45, 0
v_mov_b32 v46, 0
v_mov_b32 v47, 0
v_mov_b32 v48, 0
v_mov_b32 v49, 0
v_mov_b32 v50, 0
v_mov_b32 v51, 0
v_mov_b32 v52, 0
v_mov_b32 v53, 0
v_mov_b32 v54, 0
v_mov_b32 v55, 0
v_mov_b32 v56, 0
v_mov_b32 v57, 0
v_mov_b32 v58, 0
v_mov_b32 v59, 0
v_mov_b32 v60, 0
v_mov_b32 v61, 0
v_mov_b32 v62, 0
v_mov_b32 v63, 0
v_mov_b32 v64, 0
v_mov_b32 v65, 0
v_mov_b32 v66, 0
v_mov_b32 v67, 0
v_mov_b32 v68, 0
v_mov_b32 v69, 0
v_mov_b32 v70, 0
v_mov_b32 v71, 0
v_mov_b32 v72, 0
v_mov_b32 v73, 0
v_mov_b32 v74, 0
v_mov_b32 v75, 0
v_mov_b32 v76, 0
v_mov_b32 v77, 0
v_mov_b32 v78, 0
v_mov_b32 v79, 0
v_mov_b32 v80, 0
v_mov_b32 v81, 0
v_mov_b32 v82, 0
v_mov_b32 v83, 0
v_mov_b32 v84, 0
v_mov_b32 v85, 0
v_mov_b32 v86, 0
v_mov_b32 v87, 0
v_mov_b32 v88, 0
v_mov_b32 v89, 0
v_mov_b32 v90, 0
v_mov_b32 v91, 0
v_mov_b32 v92, 0
v_mov_b32 v93, 0
v_mov_b32 v94, 0
v_mov_b32 v95, 0
v_mov_b32 v96, 0
v_mov_b32 v97, 0
v_mov_b32 v98, 0
v_mov_b32 v99, 0
v_mov_b32 v100, 0
v_mov_b32 v101, 0
v_mov_b32 v102, 0
v_mov_b32 v103, 0
v_mov_b32 v104, 0
v_mov_b32 v105, 0
v_mov_b32 v106, 0
v_mov_b32 v107, 0
v_mov_b32 v108, 0
v_mov_b32 v109, 0
v_mov_b32 v110, 0
v_mov_b32 v111, 0
v_mov_b32 v112, 0
v_mov_b32 v113, 0
v_mov_b32 v114, 0
v_mov_b32 v115, 0
v_mov_b32 v116, 0
v_mov_b32 v117, 0
v_mov_b32 v118, 0
v_mov_b32 v119, 0
v_mov_b32 v120, 0
v_mov_b32 v121, 0
v_mov_b32 v122, 0
v_mov_b32 v123, 0
v_mov_b32 v124, 0
v_mov_b32 v125, 0
v_mov_b32 v126, 0
v_mov_b32 v127, 0
v_mov_b32 v128, 0
v_mov_b32 v129, 0
v_mov_b32 v130, 0
v_mov_b32 v131, 0
v_mov_b32 v132, 0
v_mov_b32 v133, 0
v_mov_b32 v134, 0
v_mov_b32 v135, 0
v_mov_b32 v136, 0
v_mov_b32 v137, 0
v_mov_b32 v138, 0
v_mov_b32 v139, 0
v_mov_b32 v140, 0
v_mov_b32 v141, 0
v_mov_b32 v142, 0
v_mov_b32 v143, 0
v_mov_b32 v144, 0
v_mov_b32 v145, 0
v_mov_b32 v146, 0
v_mov_b32 v147, 0
v_mov_b32 v148, 0
v_mov_b32 v149, 0
v_mov_b32 v150, 0
v_mov_b32 v151, 0
v_mov_b32 v152, 0
v_mov_b32 v153, 0
v_mov_b32 v154, 0
v_mov_b32 v155, 0
v_mov_b32 v156, 0
v_mov_b32 v157, 0
v_mov_b32 v158, 0
v_mov_b32 v159, 0
v_mov_b32 v160, 0
v_mov_b32 v161, 0
v_mov_b32 v162, 0
v_mov_b32 v163, 0
v_mov_b32 v164, 0
v_mov_b32 v165, 0
v_mov_b32 v166, 0
v_mov_b32 v167, 0
v_mov_b32 v168, 0
v_mov_b32 v169, 0
v_mov_b32 v170, 0
v_mov_b32 v171, 0
v_mov_b32 v172, 0
v_mov_b32 v173, 0
v_mov_b32 v174, 0
v_mov_b32 v175, 0
v_mov_b32 v176, 0
v_mov_b32 v177, 0
v_mov_b32 v178, 0
v_mov_b32 v179, 0
v_mov_b32 v180, 0
v_mov_b32 v181, 0
v_mov_b32 v182, 0
v_mov_b32 v183, 0
v_mov_b32 v184, 0
v_mov_b32 v185, 0
v_mov_b32 v186, 0
v_mov_b32 v187, 0
v_mov_b32 v188, 0
v_mov_b32 v189, 0
v_mov_b32 v190, 0
v_mov_b32 v191, 0
v_accvgpr_write_b32 a192, 0
v_accvgpr_write_b32 a193, 0
v_accvgpr_write_b32 a194, 0
v_accvgpr_write_b32 a195, 0
v_accvgpr_write_b32 a196, 0
v_accvgpr_write_b32 a197, 0
v_accvgpr_write_b32 a198, 0
v_accvgpr_write_b32 a199, 0
v_accvgpr_write_b32 a200, 0
v_accvgpr_write_b32 a201, 0
v_accvgpr_write_b32 a202, 0
v_accvgpr_write_b32 a203, 0
v_accvgpr_write_b32 a204, 0
v_accvgpr_write_b32 a205, 0
v_accvgpr_write_b32 a206, 0
v_accvgpr_write_b32 a207, 0
v_accvgpr_write_b32 a208, 0
v_accvgpr_write_b32 a209, 0
v_accvgpr_write_b32 a210, 0
v_accvgpr_write_b32 a211, 0
v_accvgpr_write_b32 a212, 0
v_accvgpr_write_b32 a213, 0
v_accvgpr_write_b32 a214, 0
v_accvgpr_write_b32 a215, 0
v_accvgpr_write_b32 a216, 0
v_accvgpr_write_b32 a217, 0
v_accvgpr_write_b32 a218, 0
v_accvgpr_write_b32 a219, 0
v_accvgpr_write_b32 a220, 0
v_accvgpr_write_b32 a221, 0
v_accvgpr_write_b32 a222, 0
v_accvgpr_write_b32 a223, 0
v_accvgpr_write_b32 a224, 0
v_accvgpr_write_b32 a225, 0
v_accvgpr_write_b32 a226, 0
v_accvgpr_write_b32 a227, 0
v_accvgpr_write_b32 a228, 0
v_accvgpr_write_b32 a229, 0
v_accvgpr_write_b32 a230, 0
v_accvgpr_write_b32 a231, 0
v_accvgpr_write_b32 a232, 0
v_accvgpr_write_b32 a233, 0
v_accvgpr_write_b32 a234, 0
v_accvgpr_write_b32 a235, 0
v_accvgpr_write_b32 a236, 0
v_accvgpr_write_b32 a237, 0
v_accvgpr_write_b32 a238, 0
v_accvgpr_write_b32 a239, 0
v_accvgpr_write_b32 a240, 0
v_accvgpr_write_b32 a241, 0
v_accvgpr_write_b32 a242, 0
v_accvgpr_write_b32 a243, 0
v_accvgpr_write_b32 a244, 0
v_accvgpr_write_b32 a245, 0
v_accvgpr_write_b32 a246, 0
v_accvgpr_write_b32 a247, 0
v_accvgpr_write_b32 a248, 0
v_accvgpr_write_b32 a249, 0
v_accvgpr_write_b32 a250, 0
v_accvgpr_write_b32 a251, 0
v_accvgpr_write_b32 a252, 0
v_accvgpr_write_b32 a253, 0
v_accvgpr_write_b32 a254, 0
v_accvgpr_write_b32 a255, 0
v_mov_b32 v216, 0
v_mov_b32 v217, 0
v_mov_b32 v218, 0
v_mov_b32 v219, 0
v_mov_b32 v220, 0
v_mov_b32 v221, 0
v_mov_b32 v222, 0
v_mov_b32 v223, 0
s_mov_b32 s35, 0
L_slow2:
s_add_u32 m0, s47, 0
s_add_u32 s41, s35, 0
buffer_load_dwordx4 v232, s[20:23], s41 offen lds
s_add_u32 m0, s47, 1088
s_add_u32 s41, s35, 1024
buffer_load_dwordx4 v232, s[20:23], s41 offen lds
s_add_u32 m0, s47, 2176
s_add_u32 s41, s35, 2048
buffer_load_dwordx4 v232, s[20:23], s41 offen lds
s_add_u32 m0, s47, 3264
s_add_u32 s41, s35, 3072
buffer_load_dwordx4 v232, s[20:23], s41 offen lds
s_add_u32 m0, s47, 4352
s_add_u32 s41, s35, 4096
buffer_load_dwordx4 v232, s[20:23], s41 offen lds
s_add_u32 m0, s47, 5440
s_add_u32 s41, s35, 5120
buffer_load_dwordx4 v232, s[20:23], s41 offen lds
s_add_u32 m0, s47, 6528
s_add_u32 s41, s35, 6144
buffer_load_dwordx4 v232, s[20:23], s41 offen lds
s_add_u32 m0, s47, 7616
s_add_u32 s41, s35, 7168
buffer_load_dwordx4 v232, s[20:23], s41 offen lds
s_add_u32 m0, s47, 8704
s_add_u32 s41, s35, 0
buffer_load_dwordx4 v233, s[24:27], s41 offen lds
s_add_u32 m0, s47, 9760
s_add_u32 s41, s35, 256
buffer_load_dwordx4 v233, s[24:27], s41 offen lds
s_add_u32 m0, s47, 10816
s_add_u32 s41, s35, 512
buffer_load_dwordx4 v233, s[24:27], s41 offen lds
s_add_u32 m0, s47, 11872
s_add_u32 s41, s35, 768
buffer_load_dwordx4 v233, s[24:27], s41 offen lds
s_add_u32 m0, s47, 12928
s_add_u32 s41, s35, 1024
buffer_load_dwordx4 v233, s[24:27], s41 offen lds
s_add_u32 m0, s47, 13984
s_add_u32 s41, s35, 1280
buffer_load_dwordx4 v233, s[24:27], s41 offen lds
s_add_u32 m0, s47, 15040
s_add_u32 s41, s35, 1536
buffer_load_dwordx4 v233, s[24:27], s41 offen lds
s_add_u32 m0, s47, 16096
s_add_u32 s41, s35, 1792
buffer_load_dwordx4 v233, s[24:27], s41 offen lds
s_waitcnt vmcnt(0)
ds_read_b128 a[128:131], v224 offset:0
ds_read_b128 a[132:135], v224 offset:64
ds_read_b128 a[136:139], v224 offset:128
ds_read_b128 a[140:143], v224 offset:192
ds_read_b128 a[144:147], v224 offset:4352
ds_read_b128 a[148:151], v224 offset:4416
ds_read_b128 a[152:155], v224 offset:4480
ds_read_b128 a[156:159], v224 offset:4544
ds_read_b64_tr_b16 a[160:161], v225 offset:0
ds_read_b64_tr_b16 a[162:163], v225 offset:512
ds_read_b64_tr_b16 a[164:165], v225 offset:32
ds_read_b64_tr_b16 a[166:167], v225 offset:544
ds_read_b64_tr_b16 a[168:169], v225 offset:64
ds_read_b64_tr_b16 a[170:171], v225 offset:576
ds_read_b64_tr_b16 a[172:173], v225 offset:96
ds_read_b64_tr_b16 a[174:175], v225 offset:608
ds_read_b64_tr_b16 a[176:177], v225 offset:128
ds_read_b64_tr_b16 a[178:179], v225 offset:640
ds_read_b64_tr_b16 a[180:181], v225 offset:160
ds_read_b64_tr_b16 a[182:183], v225 offset:672
ds_read_b64_tr_b16 a[184:185], v225 offset:192
ds_read_b64_tr_b16 a[186:187], v225 offset:704
ds_read_b64_tr_b16 a[188:189], v225 offset:224
ds_read_b64_tr_b16 a[190:191], v225 offset:736
s_waitcnt lgkmcnt(0)
v_mfma_f32_16x16x32_bf16 v[192:195], a[128:131], a[0:3], 0
v_mfma_f32_16x16x32_bf16 v[192:195], a[132:135], a[4:7], v[192:195]
v_mfma_f32_16x16x32_bf16 v[192:195], a[136:139], a[8:11], v[192:195]
v_mfma_f32_16x16x32_bf16 v[192:195], a[140:143], a[12:15], v[192:195]
v_mfma_f32_16x16x32_bf16 v[196:199], a[144:147], a[0:3], 0
v_mfma_f32_16x16x32_bf16 v[196:199], a[148:151], a[4:7], v[196:199]
v_mfma_f32_16x16x32_bf16 v[196:199], a[152:155], a[8:11], v[196:199]
v_mfma_f32_16x16x32_bf16 v[196:199], a[156:159], a[12:15], v[196:199]
s_nop 3
v_fma_f32 v192, v192, s38, -v240
v_fma_f32 v193, v193, s38, -v240
v_fma_f32 v194, v194, s38, -v240
v_fma_f32 v195, v195, s38, -v240
v_fma_f32 v196, v196, s38, -v240
v_fma_f32 v197, v197, s38, -v240
v_fma_f32 v198, v198, s38, -v240
v_fma_f32 v199, v199, s38, -v240
v_exp_f32 v192, v192
v_exp_f32 v193, v193
v_exp_f32 v194, v194
v_exp_f32 v195, v195
v_exp_f32 v196, v196
v_exp_f32 v197, v197
v_exp_f32 v198, v198
v_exp_f32 v199, v199
v_add_f32 v216, v216, v192
v_add_f32 v216, v216, v193
v_add_f32 v216, v216, v194
v_add_f32 v216, v216, v195
v_add_f32 v216, v216, v196
v_add_f32 v216, v216, v197
v_add_f32 v216, v216, v198
v_add_f32 v216, v216, v199
v_cvt_pk_bf16_f32 v208, v192, v193
v_cvt_pk_bf16_f32 v209, v194, v195
v_cvt_pk_bf16_f32 v210, v196, v197
v_cvt_pk_bf16_f32 v211, v198, v199
s_nop 1
v_mfma_f32_16x16x32_bf16 a[192:195], a[160:163], v[208:211], a[192:195]
v_mfma_f32_16x16x32_bf16 a[196:199], a[164:167], v[208:211], a[196:199]
v_mfma_f32_16x16x32_bf16 a[200:203], a[168:171], v[208:211], a[200:203]
v_mfma_f32_16x16x32_bf16 a[204:207], a[172:175], v[208:211], a[204:207]
v_mfma_f32_16x16x32_bf16 a[208:211], a[176:179], v[208:211], a[208:211]
v_mfma_f32_16x16x32_bf16 a[212:215], a[180:183], v[208:211], a[212:215]
v_mfma_f32_16x16x32_bf16 a[216:219], a[184:187], v[208:211], a[216:219]
v_mfma_f32_16x16x32_bf16 a[220:223], a[188:191], v[208:211], a[220:223]
v_mfma_f32_16x16x32_bf16 v[192:195], a[128:131], a[16:19], 0
v_mfma_f32_16x16x32_bf16 v[192:195], a[132:135], a[20:23], v[192:195]
v_mfma_f32_16x16x32_bf16 v[192:195], a[136:139], a[24:27], v[192:195]
v_mfma_f32_16x16x32_bf16 v[192:195], a[140:143], a[28:31], v[192:195]
v_mfma_f32_16x16x32_bf16 v[196:199], a[144:147], a[16:19], 0
v_mfma_f32_16x16x32_bf16 v[196:199], a[148:151], a[20:23], v[196:199]
v_mfma_f32_16x16x32_bf16 v[196:199], a[152:155], a[24:27], v[196:199]
v_mfma_f32_16x16x32_bf16 v[196:199], a[156:159], a[28:31], v[196:199]
s_nop 3
v_fma_f32 v192, v192, s38, -v241
v_fma_f32 v193, v193, s38, -v241
v_fma_f32 v194, v194, s38, -v241
v_fma_f32 v195, v195, s38, -v241
v_fma_f32 v196, v196, s38, -v241
v_fma_f32 v197, v197, s38, -v241
v_fma_f32 v198, v198, s38, -v241
v_fma_f32 v199, v199, s38, -v241
v_exp_f32 v192, v192
v_exp_f32 v193, v193
v_exp_f32 v194, v194
v_exp_f32 v195, v195
v_exp_f32 v196, v196
v_exp_f32 v197, v197
v_exp_f32 v198, v198
v_exp_f32 v199, v199
v_add_f32 v217, v217, v192
v_add_f32 v217, v217, v193
v_add_f32 v217, v217, v194
v_add_f32 v217, v217, v195
v_add_f32 v217, v217, v196
v_add_f32 v217, v217, v197
v_add_f32 v217, v217, v198
v_add_f32 v217, v217, v199
v_cvt_pk_bf16_f32 v208, v192, v193
v_cvt_pk_bf16_f32 v209, v194, v195
v_cvt_pk_bf16_f32 v210, v196, v197
v_cvt_pk_bf16_f32 v211, v198, v199
s_nop 1
v_mfma_f32_16x16x32_bf16 a[224:227], a[160:163], v[208:211], a[224:227]
v_mfma_f32_16x16x32_bf16 a[228:231], a[164:167], v[208:211], a[228:231]
v_mfma_f32_16x16x32_bf16 a[232:235], a[168:171], v[208:211], a[232:235]
v_mfma_f32_16x16x32_bf16 a[236:239], a[172:175], v[208:211], a[236:239]
v_mfma_f32_16x16x32_bf16 a[240:243], a[176:179], v[208:211], a[240:243]
v_mfma_f32_16x16x32_bf16 a[244:247], a[180:183], v[208:211], a[244:247]
v_mfma_f32_16x16x32_bf16 a[248:251], a[184:187], v[208:211], a[248:251]
v_mfma_f32_16x16x32_bf16 a[252:255], a[188:191], v[208:211], a[252:255]
v_mfma_f32_16x16x32_bf16 v[192:195], a[128:131], a[32:35], 0
v_mfma_f32_16x16x32_bf16 v[192:195], a[132:135], a[36:39], v[192:195]
v_mfma_f32_16x16x32_bf16 v[192:195], a[136:139], a[40:43], v[192:195]
v_mfma_f32_16x16x32_bf16 v[192:195], a[140:143], a[44:47], v[192:195]
v_mfma_f32_16x16x32_bf16 v[196:199], a[144:147], a[32:35], 0
v_mfma_f32_16x16x32_bf16 v[196:199], a[148:151], a[36:39], v[196:199]
v_mfma_f32_16x16x32_bf16 v[196:199], a[152:155], a[40:43], v[196:199]
v_mfma_f32_16x16x32_bf16 v[196:199], a[156:159], a[44:47], v[196:199]
s_nop 3
v_fma_f32 v192, v192, s38, -v242
v_fma_f32 v193, v193, s38, -v242
v_fma_f32 v194, v194, s38, -v242
v_fma_f32 v195, v195, s38, -v242
v_fma_f32 v196, v196, s38, -v242
v_fma_f32 v197, v197, s38, -v242
v_fma_f32 v198, v198, s38, -v242
v_fma_f32 v199, v199, s38, -v242
v_exp_f32 v192, v192
v_exp_f32 v193, v193
v_exp_f32 v194, v194
v_exp_f32 v195, v195
v_exp_f32 v196, v196
v_exp_f32 v197, v197
v_exp_f32 v198, v198
v_exp_f32 v199, v199
v_add_f32 v218, v218, v192
v_add_f32 v218, v218, v193
v_add_f32 v218, v218, v194
v_add_f32 v218, v218, v195
v_add_f32 v218, v218, v196
v_add_f32 v218, v218, v197
v_add_f32 v218, v218, v198
v_add_f32 v218, v218, v199
v_cvt_pk_bf16_f32 v208, v192, v193
v_cvt_pk_bf16_f32 v209, v194, v195
v_cvt_pk_bf16_f32 v210, v196, v197
v_cvt_pk_bf16_f32 v211, v198, v199
s_nop 1
v_mfma_f32_16x16x32_bf16 v[0:3], a[160:163], v[208:211], v[0:3]
v_mfma_f32_16x16x32_bf16 v[4:7], a[164:167], v[208:211], v[4:7]
v_mfma_f32_16x16x32_bf16 v[8:11], a[168:171], v[208:211], v[8:11]
v_mfma_f32_16x16x32_bf16 v[12:15], a[172:175], v[208:211], v[12:15]
v_mfma_f32_16x16x32_bf16 v[16:19], a[176:179], v[208:211], v[16:19]
v_mfma_f32_16x16x32_bf16 v[20:23], a[180:183], v[208:211], v[20:23]
v_mfma_f32_16x16x32_bf16 v[24:27], a[184:187], v[208:211], v[24:27]
v_mfma_f32_16x16x32_bf16 v[28:31], a[188:191], v[208:211], v[28:31]
v_mfma_f32_16x16x32_bf16 v[192:195], a[128:131], a[48:51], 0
v_mfma_f32_16x16x32_bf16 v[192:195], a[132:135], a[52:55], v[192:195]
v_mfma_f32_16x16x32_bf16 v[192:195], a[136:139], a[56:59], v[192:195]
v_mfma_f32_16x16x32_bf16 v[192:195], a[140:143], a[60:63], v[192:195]
v_mfma_f32_16x16x32_bf16 v[196:199], a[144:147], a[48:51], 0
v_mfma_f32_16x16x32_bf16 v[196:199], a[148:151], a[52:55], v[196:199]
v_mfma_f32_16x16x32_bf16 v[196:199], a[152:155], a[56:59], v[196:199]
v_mfma_f32_16x16x32_bf16 v[196:199], a[156:159], a[60:63], v[196:199]
s_nop 3
v_fma_f32 v192, v192, s38, -v243
v_fma_f32 v193, v193, s38, -v243
v_fma_f32 v194, v194, s38, -v243
v_fma_f32 v195, v195, s38, -v243
v_fma_f32 v196, v196, s38, -v243
v_fma_f32 v197, v197, s38, -v243
v_fma_f32 v198, v198, s38, -v243
v_fma_f32 v199, v199, s38, -v243
v_exp_f32 v192, v192
v_exp_f32 v193, v193
v_exp_f32 v194, v194
v_exp_f32 v195, v195
v_exp_f32 v196, v196
v_exp_f32 v197, v197
v_exp_f32 v198, v198
v_exp_f32 v199, v199
v_add_f32 v219, v219, v192
v_add_f32 v219, v219, v193
v_add_f32 v219, v219, v194
v_add_f32 v219, v219, v195
v_add_f32 v219, v219, v196
v_add_f32 v219, v219, v197
v_add_f32 v219, v219, v198
v_add_f32 v219, v219, v199
v_cvt_pk_bf16_f32 v208, v192, v193
v_cvt_pk_bf16_f32 v209, v194, v195
v_cvt_pk_bf16_f32 v210, v196, v197
v_cvt_pk_bf16_f32 v211, v198, v199
s_nop 1
v_mfma_f32_16x16x32_bf16 v[32:35], a[160:163], v[208:211], v[32:35]
v_mfma_f32_16x16x32_bf16 v[36:39], a[164:167], v[208:211], v[36:39]
v_mfma_f32_16x16x32_bf16 v[40:43], a[168:171], v[208:211], v[40:43]
v_mfma_f32_16x16x32_bf16 v[44:47], a[172:175], v[208:211], v[44:47]
v_mfma_f32_16x16x32_bf16 v[48:51], a[176:179], v[208:211], v[48:51]
v_mfma_f32_16x16x32_bf16 v[52:55], a[180:183], v[208:211], v[52:55]
v_mfma_f32_16x16x32_bf16 v[56:59], a[184:187], v[208:211], v[56:59]
v_mfma_f32_16x16x32_bf16 v[60:63], a[188:191], v[208:211], v[60:63]
v_mfma_f32_16x16x32_bf16 v[192:195], a[128:131], a[64:67], 0
v_mfma_f32_16x16x32_bf16 v[192:195], a[132:135], a[68:71], v[192:195]
v_mfma_f32_16x16x32_bf16 v[192:195], a[136:139], a[72:75], v[192:195]
v_mfma_f32_16x16x32_bf16 v[192:195], a[140:143], a[76:79], v[192:195]
v_mfma_f32_16x16x32_bf16 v[196:199], a[144:147], a[64:67], 0
v_mfma_f32_16x16x32_bf16 v[196:199], a[148:151], a[68:71], v[196:199]
v_mfma_f32_16x16x32_bf16 v[196:199], a[152:155], a[72:75], v[196:199]
v_mfma_f32_16x16x32_bf16 v[196:199], a[156:159], a[76:79], v[196:199]
s_nop 3
v_fma_f32 v192, v192, s38, -v244
v_fma_f32 v193, v193, s38, -v244
v_fma_f32 v194, v194, s38, -v244
v_fma_f32 v195, v195, s38, -v244
v_fma_f32 v196, v196, s38, -v244
v_fma_f32 v197, v197, s38, -v244
v_fma_f32 v198, v198, s38, -v244
v_fma_f32 v199, v199, s38, -v244
v_exp_f32 v192, v192
v_exp_f32 v193, v193
v_exp_f32 v194, v194
v_exp_f32 v195, v195
v_exp_f32 v196, v196
v_exp_f32 v197, v197
v_exp_f32 v198, v198
v_exp_f32 v199, v199
v_add_f32 v220, v220, v192
v_add_f32 v220, v220, v193
v_add_f32 v220, v220, v194
v_add_f32 v220, v220, v195
v_add_f32 v220, v220, v196
v_add_f32 v220, v220, v197
v_add_f32 v220, v220, v198
v_add_f32 v220, v220, v199
v_cvt_pk_bf16_f32 v208, v192, v193
v_cvt_pk_bf16_f32 v209, v194, v195
v_cvt_pk_bf16_f32 v210, v196, v197
v_cvt_pk_bf16_f32 v211, v198, v199
s_nop 1
v_mfma_f32_16x16x32_bf16 v[64:67], a[160:163], v[208:211], v[64:67]
v_mfma_f32_16x16x32_bf16 v[68:71], a[164:167], v[208:211], v[68:71]
v_mfma_f32_16x16x32_bf16 v[72:75], a[168:171], v[208:211], v[72:75]
v_mfma_f32_16x16x32_bf16 v[76:79], a[172:175], v[208:211], v[76:79]
v_mfma_f32_16x16x32_bf16 v[80:83], a[176:179], v[208:211], v[80:83]
v_mfma_f32_16x16x32_bf16 v[84:87], a[180:183], v[208:211], v[84:87]
v_mfma_f32_16x16x32_bf16 v[88:91], a[184:187], v[208:211], v[88:91]
v_mfma_f32_16x16x32_bf16 v[92:95], a[188:191], v[208:211], v[92:95]
v_mfma_f32_16x16x32_bf16 v[192:195], a[128:131], a[80:83], 0
v_mfma_f32_16x16x32_bf16 v[192:195], a[132:135], a[84:87], v[192:195]
v_mfma_f32_16x16x32_bf16 v[192:195], a[136:139], a[88:91], v[192:195]
v_mfma_f32_16x16x32_bf16 v[192:195], a[140:143], a[92:95], v[192:195]
v_mfma_f32_16x16x32_bf16 v[196:199], a[144:147], a[80:83], 0
v_mfma_f32_16x16x32_bf16 v[196:199], a[148:151], a[84:87], v[196:199]
v_mfma_f32_16x16x32_bf16 v[196:199], a[152:155], a[88:91], v[196:199]
v_mfma_f32_16x16x32_bf16 v[196:199], a[156:159], a[92:95], v[196:199]
s_nop 3
v_fma_f32 v192, v192, s38, -v245
v_fma_f32 v193, v193, s38, -v245
v_fma_f32 v194, v194, s38, -v245
v_fma_f32 v195, v195, s38, -v245
v_fma_f32 v196, v196, s38, -v245
v_fma_f32 v197, v197, s38, -v245
v_fma_f32 v198, v198, s38, -v245
v_fma_f32 v199, v199, s38, -v245
v_exp_f32 v192, v192
v_exp_f32 v193, v193
v_exp_f32 v194, v194
v_exp_f32 v195, v195
v_exp_f32 v196, v196
v_exp_f32 v197, v197
v_exp_f32 v198, v198
v_exp_f32 v199, v199
v_add_f32 v221, v221, v192
v_add_f32 v221, v221, v193
v_add_f32 v221, v221, v194
v_add_f32 v221, v221, v195
v_add_f32 v221, v221, v196
v_add_f32 v221, v221, v197
v_add_f32 v221, v221, v198
v_add_f32 v221, v221, v199
v_cvt_pk_bf16_f32 v208, v192, v193
v_cvt_pk_bf16_f32 v209, v194, v195
v_cvt_pk_bf16_f32 v210, v196, v197
v_cvt_pk_bf16_f32 v211, v198, v199
s_nop 1
v_mfma_f32_16x16x32_bf16 v[96:99], a[160:163], v[208:211], v[96:99]
v_mfma_f32_16x16x32_bf16 v[100:103], a[164:167], v[208:211], v[100:103]
v_mfma_f32_16x16x32_bf16 v[104:107], a[168:171], v[208:211], v[104:107]
v_mfma_f32_16x16x32_bf16 v[108:111], a[172:175], v[208:211], v[108:111]
v_mfma_f32_16x16x32_bf16 v[112:115], a[176:179], v[208:211], v[112:115]
v_mfma_f32_16x16x32_bf16 v[116:119], a[180:183], v[208:211], v[116:119]
v_mfma_f32_16x16x32_bf16 v[120:123], a[184:187], v[208:211], v[120:123]
v_mfma_f32_16x16x32_bf16 v[124:127], a[188:191], v[208:211], v[124:127]
v_mfma_f32_16x16x32_bf16 v[192:195], a[128:131], a[96:99], 0
v_mfma_f32_16x16x32_bf16 v[192:195], a[132:135], a[100:103], v[192:195]
v_mfma_f32_16x16x32_bf16 v[192:195], a[136:139], a[104:107], v[192:195]
v_mfma_f32_16x16x32_bf16 v[192:195], a[140:143], a[108:111], v[192:195]
v_mfma_f32_16x16x32_bf16 v[196:199], a[144:147], a[96:99], 0
v_mfma_f32_16x16x32_bf16 v[196:199], a[148:151], a[100:103], v[196:199]
v_mfma_f32_16x16x32_bf16 v[196:199], a[152:155], a[104:107], v[196:199]
v_mfma_f32_16x16x32_bf16 v[196:199], a[156:159], a[108:111], v[196:199]
s_nop 3
v_fma_f32 v192, v192, s38, -v246
v_fma_f32 v193, v193, s38, -v246
v_fma_f32 v194, v194, s38, -v246
v_fma_f32 v195, v195, s38, -v246
v_fma_f32 v196, v196, s38, -v246
v_fma_f32 v197, v197, s38, -v246
v_fma_f32 v198, v198, s38, -v246
v_fma_f32 v199, v199, s38, -v246
v_exp_f32 v192, v192
v_exp_f32 v193, v193
v_exp_f32 v194, v194
v_exp_f32 v195, v195
v_exp_f32 v196, v196
v_exp_f32 v197, v197
v_exp_f32 v198, v198
v_exp_f32 v199, v199
v_add_f32 v222, v222, v192
v_add_f32 v222, v222, v193
v_add_f32 v222, v222, v194
v_add_f32 v222, v222, v195
v_add_f32 v222, v222, v196
v_add_f32 v222, v222, v197
v_add_f32 v222, v222, v198
v_add_f32 v222, v222, v199
v_cvt_pk_bf16_f32 v208, v192, v193
v_cvt_pk_bf16_f32 v209, v194, v195
v_cvt_pk_bf16_f32 v210, v196, v197
v_cvt_pk_bf16_f32 v211, v198, v199
s_nop 1
v_mfma_f32_16x16x32_bf16 v[128:131], a[160:163], v[208:211], v[128:131]
v_mfma_f32_16x16x32_bf16 v[132:135], a[164:167], v[208:211], v[132:135]
v_mfma_f32_16x16x32_bf16 v[136:139], a[168:171], v[208:211], v[136:139]
v_mfma_f32_16x16x32_bf16 v[140:143], a[172:175], v[208:211], v[140:143]
v_mfma_f32_16x16x32_bf16 v[144:147], a[176:179], v[208:211], v[144:147]
v_mfma_f32_16x16x32_bf16 v[148:151], a[180:183], v[208:211], v[148:151]
v_mfma_f32_16x16x32_bf16 v[152:155], a[184:187], v[208:211], v[152:155]
v_mfma_f32_16x16x32_bf16 v[156:159], a[188:191], v[208:211], v[156:159]
v_mfma_f32_16x16x32_bf16 v[192:195], a[128:131], a[112:115], 0
v_mfma_f32_16x16x32_bf16 v[192:195], a[132:135], a[116:119], v[192:195]
v_mfma_f32_16x16x32_bf16 v[192:195], a[136:139], a[120:123], v[192:195]
v_mfma_f32_16x16x32_bf16 v[192:195], a[140:143], a[124:127], v[192:195]
v_mfma_f32_16x16x32_bf16 v[196:199], a[144:147], a[112:115], 0
v_mfma_f32_16x16x32_bf16 v[196:199], a[148:151], a[116:119], v[196:199]
v_mfma_f32_16x16x32_bf16 v[196:199], a[152:155], a[120:123], v[196:199]
v_mfma_f32_16x16x32_bf16 v[196:199], a[156:159], a[124:127], v[196:199]
s_nop 3
v_fma_f32 v192, v192, s38, -v247
v_fma_f32 v193, v193, s38, -v247
v_fma_f32 v194, v194, s38, -v247
v_fma_f32 v195, v195, s38, -v247
v_fma_f32 v196, v196, s38, -v247
v_fma_f32 v197, v197, s38, -v247
v_fma_f32 v198, v198, s38, -v247
v_fma_f32 v199, v199, s38, -v247
v_exp_f32 v192, v192
v_exp_f32 v193, v193
v_exp_f32 v194, v194
v_exp_f32 v195, v195
v_exp_f32 v196, v196
v_exp_f32 v197, v197
v_exp_f32 v198, v198
v_exp_f32 v199, v199
v_add_f32 v223, v223, v192
v_add_f32 v223, v223, v193
v_add_f32 v223, v223, v194
v_add_f32 v223, v223, v195
v_add_f32 v223, v223, v196
v_add_f32 v223, v223, v197
v_add_f32 v223, v223, v198
v_add_f32 v223, v223, v199
v_cvt_pk_bf16_f32 v208, v192, v193
v_cvt_pk_bf16_f32 v209, v194, v195
v_cvt_pk_bf16_f32 v210, v196, v197
v_cvt_pk_bf16_f32 v211, v198, v199
s_nop 1
v_mfma_f32_16x16x32_bf16 v[160:163], a[160:163], v[208:211], v[160:163]
v_mfma_f32_16x16x32_bf16 v[164:167], a[164:167], v[208:211], v[164:167]
v_mfma_f32_16x16x32_bf16 v[168:171], a[168:171], v[208:211], v[168:171]
v_mfma_f32_16x16x32_bf16 v[172:175], a[172:175], v[208:211], v[172:175]
v_mfma_f32_16x16x32_bf16 v[176:179], a[176:179], v[208:211], v[176:179]
v_mfma_f32_16x16x32_bf16 v[180:183], a[180:183], v[208:211], v[180:183]
v_mfma_f32_16x16x32_bf16 v[184:187], a[184:187], v[208:211], v[184:187]
v_mfma_f32_16x16x32_bf16 v[188:191], a[188:191], v[208:211], v[188:191]
s_add_u32 s35, s35, 8192
s_cmp_lt_u32 s35, 131072
s_cbranch_scc1 L_slow2
s_nop 7
v_mbcnt_lo_u32_b32 v240, -1, 0
v_mbcnt_hi_u32_b32 v240, -1, v240
v_and_b32 v241, 15, v240
v_lshrrev_b32 v242, 4, v240
v_mul_u32_u24 v226, 272, v241
v_lshl_add_u32 v226, v242, 3, v226
v_add_u32 v226, s47, v226
v_mul_u32_u24 v227, 272, v242
v_lshl_add_u32 v227, v241, 4, v227
v_add_u32 v227, s47, v227
s_lshl_b32 s41, s3, 15
v_lshlrev_b32 v229, 4, v240
v_add_u32 v229, s41, v229
v_mov_b32 v230, v216
s_nop 1
v_permlane32_swap_b32 v216, v230
v_add_f32 v216, v216, v230
v_mov_b32 v230, v216
s_nop 1
v_permlane16_swap_b32 v216, v230
v_add_f32 v216, v216, v230
v_rcp_f32 v228, v216
v_accvgpr_read_b32 v232, a192
v_accvgpr_read_b32 v233, a193
v_accvgpr_read_b32 v234, a194
v_accvgpr_read_b32 v235, a195
v_pk_mul_f32 v[232:233], v[232:233], v[228:229] op_sel_hi:[1,0]
v_pk_mul_f32 v[234:235], v[234:235], v[228:229] op_sel_hi:[1,0]
v_cvt_pk_bf16_f32 v232, v232, v233
v_cvt_pk_bf16_f32 v233, v234, v235
ds_write_b64 v226, v[232:233] offset:0
v_accvgpr_read_b32 v236, a196
v_accvgpr_read_b32 v237, a197
v_accvgpr_read_b32 v238, a198
v_accvgpr_read_b32 v239, a199
v_pk_mul_f32 v[236:237], v[236:237], v[228:229] op_sel_hi:[1,0]
v_pk_mul_f32 v[238:239], v[238:239], v[228:229] op_sel_hi:[1,0]
v_cvt_pk_bf16_f32 v236, v236, v237
v_cvt_pk_bf16_f32 v237, v238, v239
ds_write_b64 v226, v[236:237] offset:32
v_accvgpr_read_b32 v232, a200
v_accvgpr_read_b32 v233, a201
v_accvgpr_read_b32 v234, a202
v_accvgpr_read_b32 v235, a203
v_pk_mul_f32 v[232:233], v[232:233], v[228:229] op_sel_hi:[1,0]
v_pk_mul_f32 v[234:235], v[234:235], v[228:229] op_sel_hi:[1,0]
v_cvt_pk_bf16_f32 v232, v232, v233
v_cvt_pk_bf16_f32 v233, v234, v235
ds_write_b64 v226, v[232:233] offset:64
v_accvgpr_read_b32 v236, a204
v_accvgpr_read_b32 v237, a205
v_accvgpr_read_b32 v238, a206
v_accvgpr_read_b32 v239, a207
v_pk_mul_f32 v[236:237], v[236:237], v[228:229] op_sel_hi:[1,0]
v_pk_mul_f32 v[238:239], v[238:239], v[228:229] op_sel_hi:[1,0]
v_cvt_pk_bf16_f32 v236, v236, v237
v_cvt_pk_bf16_f32 v237, v238, v239
ds_write_b64 v226, v[236:237] offset:96
v_accvgpr_read_b32 v232, a208
v_accvgpr_read_b32 v233, a209
v_accvgpr_read_b32 v234, a210
v_accvgpr_read_b32 v235, a211
v_pk_mul_f32 v[232:233], v[232:233], v[228:229] op_sel_hi:[1,0]
v_pk_mul_f32 v[234:235], v[234:235], v[228:229] op_sel_hi:[1,0]
v_cvt_pk_bf16_f32 v232, v232, v233
v_cvt_pk_bf16_f32 v233, v234, v235
ds_write_b64 v226, v[232:233] offset:128
v_accvgpr_read_b32 v236, a212
v_accvgpr_read_b32 v237, a213
v_accvgpr_read_b32 v238, a214
v_accvgpr_read_b32 v239, a215
v_pk_mul_f32 v[236:237], v[236:237], v[228:229] op_sel_hi:[1,0]
v_pk_mul_f32 v[238:239], v[238:239], v[228:229] op_sel_hi:[1,0]
v_cvt_pk_bf16_f32 v236, v236, v237
v_cvt_pk_bf16_f32 v237, v238, v239
ds_write_b64 v226, v[236:237] offset:160
v_accvgpr_read_b32 v232, a216
v_accvgpr_read_b32 v233, a217
v_accvgpr_read_b32 v234, a218
v_accvgpr_read_b32 v235, a219
v_pk_mul_f32 v[232:233], v[232:233], v[228:229] op_sel_hi:[1,0]
v_pk_mul_f32 v[234:235], v[234:235], v[228:229] op_sel_hi:[1,0]
v_cvt_pk_bf16_f32 v232, v232, v233
v_cvt_pk_bf16_f32 v233, v234, v235
ds_write_b64 v226, v[232:233] offset:192
v_accvgpr_read_b32 v236, a220
v_accvgpr_read_b32 v237, a221
v_accvgpr_read_b32 v238, a222
v_accvgpr_read_b32 v239, a223
v_pk_mul_f32 v[236:237], v[236:237], v[228:229] op_sel_hi:[1,0]
v_pk_mul_f32 v[238:239], v[238:239], v[228:229] op_sel_hi:[1,0]
v_cvt_pk_bf16_f32 v236, v236, v237
v_cvt_pk_bf16_f32 v237, v238, v239
ds_write_b64 v226, v[236:237] offset:224
ds_read_b128 v[240:243], v227 offset:0
ds_read_b128 v[244:247], v227 offset:1088
ds_read_b128 v[248:251], v227 offset:2176
ds_read_b128 v[252:255], v227 offset:3264
v_add_u32 v231, 0, v229
s_waitcnt lgkmcnt(0)
buffer_store_dwordx4 v[240:243], v231, s[28:31], 0 offen offset:0 nt
buffer_store_dwordx4 v[244:247], v231, s[28:31], 0 offen offset:1024 nt
buffer_store_dwordx4 v[248:251], v231, s[28:31], 0 offen offset:2048 nt
buffer_store_dwordx4 v[252:255], v231, s[28:31], 0 offen offset:3072 nt
v_mov_b32 v230, v217
s_nop 1
v_permlane32_swap_b32 v217, v230
v_add_f32 v217, v217, v230
v_mov_b32 v230, v217
s_nop 1
v_permlane16_swap_b32 v217, v230
v_add_f32 v217, v217, v230
v_rcp_f32 v228, v217
v_accvgpr_read_b32 v232, a224
v_accvgpr_read_b32 v233, a225
v_accvgpr_read_b32 v234, a226
v_accvgpr_read_b32 v235, a227
v_pk_mul_f32 v[232:233], v[232:233], v[228:229] op_sel_hi:[1,0]
v_pk_mul_f32 v[234:235], v[234:235], v[228:229] op_sel_hi:[1,0]
v_cvt_pk_bf16_f32 v232, v232, v233
v_cvt_pk_bf16_f32 v233, v234, v235
ds_write_b64 v226, v[232:233] offset:0
v_accvgpr_read_b32 v236, a228
v_accvgpr_read_b32 v237, a229
v_accvgpr_read_b32 v238, a230
v_accvgpr_read_b32 v239, a231
v_pk_mul_f32 v[236:237], v[236:237], v[228:229] op_sel_hi:[1,0]
v_pk_mul_f32 v[238:239], v[238:239], v[228:229] op_sel_hi:[1,0]
v_cvt_pk_bf16_f32 v236, v236, v237
v_cvt_pk_bf16_f32 v237, v238, v239
ds_write_b64 v226, v[236:237] offset:32
v_accvgpr_read_b32 v232, a232
v_accvgpr_read_b32 v233, a233
v_accvgpr_read_b32 v234, a234
v_accvgpr_read_b32 v235, a235
v_pk_mul_f32 v[232:233], v[232:233], v[228:229] op_sel_hi:[1,0]
v_pk_mul_f32 v[234:235], v[234:235], v[228:229] op_sel_hi:[1,0]
v_cvt_pk_bf16_f32 v232, v232, v233
v_cvt_pk_bf16_f32 v233, v234, v235
ds_write_b64 v226, v[232:233] offset:64
v_accvgpr_read_b32 v236, a236
v_accvgpr_read_b32 v237, a237
v_accvgpr_read_b32 v238, a238
v_accvgpr_read_b32 v239, a239
v_pk_mul_f32 v[236:237], v[236:237], v[228:229] op_sel_hi:[1,0]
v_pk_mul_f32 v[238:239], v[238:239], v[228:229] op_sel_hi:[1,0]
v_cvt_pk_bf16_f32 v236, v236, v237
v_cvt_pk_bf16_f32 v237, v238, v239
ds_write_b64 v226, v[236:237] offset:96
v_accvgpr_read_b32 v232, a240
v_accvgpr_read_b32 v233, a241
v_accvgpr_read_b32 v234, a242
v_accvgpr_read_b32 v235, a243
v_pk_mul_f32 v[232:233], v[232:233], v[228:229] op_sel_hi:[1,0]
v_pk_mul_f32 v[234:235], v[234:235], v[228:229] op_sel_hi:[1,0]
v_cvt_pk_bf16_f32 v232, v232, v233
v_cvt_pk_bf16_f32 v233, v234, v235
ds_write_b64 v226, v[232:233] offset:128
v_accvgpr_read_b32 v236, a244
v_accvgpr_read_b32 v237, a245
v_accvgpr_read_b32 v238, a246
v_accvgpr_read_b32 v239, a247
v_pk_mul_f32 v[236:237], v[236:237], v[228:229] op_sel_hi:[1,0]
v_pk_mul_f32 v[238:239], v[238:239], v[228:229] op_sel_hi:[1,0]
v_cvt_pk_bf16_f32 v236, v236, v237
v_cvt_pk_bf16_f32 v237, v238, v239
ds_write_b64 v226, v[236:237] offset:160
v_accvgpr_read_b32 v232, a248
v_accvgpr_read_b32 v233, a249
v_accvgpr_read_b32 v234, a250
v_accvgpr_read_b32 v235, a251
v_pk_mul_f32 v[232:233], v[232:233], v[228:229] op_sel_hi:[1,0]
v_pk_mul_f32 v[234:235], v[234:235], v[228:229] op_sel_hi:[1,0]
v_cvt_pk_bf16_f32 v232, v232, v233
v_cvt_pk_bf16_f32 v233, v234, v235
ds_write_b64 v226, v[232:233] offset:192
v_accvgpr_read_b32 v236, a252
v_accvgpr_read_b32 v237, a253
v_accvgpr_read_b32 v238, a254
v_accvgpr_read_b32 v239, a255
v_pk_mul_f32 v[236:237], v[236:237], v[228:229] op_sel_hi:[1,0]
v_pk_mul_f32 v[238:239], v[238:239], v[228:229] op_sel_hi:[1,0]
v_cvt_pk_bf16_f32 v236, v236, v237
v_cvt_pk_bf16_f32 v237, v238, v239
ds_write_b64 v226, v[236:237] offset:224
ds_read_b128 v[240:243], v227 offset:0
ds_read_b128 v[244:247], v227 offset:1088
ds_read_b128 v[248:251], v227 offset:2176
ds_read_b128 v[252:255], v227 offset:3264
v_add_u32 v231, 4096, v229
s_waitcnt lgkmcnt(0)
buffer_store_dwordx4 v[240:243], v231, s[28:31], 0 offen offset:0 nt
buffer_store_dwordx4 v[244:247], v231, s[28:31], 0 offen offset:1024 nt
buffer_store_dwordx4 v[248:251], v231, s[28:31], 0 offen offset:2048 nt
buffer_store_dwordx4 v[252:255], v231, s[28:31], 0 offen offset:3072 nt
v_mov_b32 v230, v218
s_nop 1
v_permlane32_swap_b32 v218, v230
v_add_f32 v218, v218, v230
v_mov_b32 v230, v218
s_nop 1
v_permlane16_swap_b32 v218, v230
v_add_f32 v218, v218, v230
v_rcp_f32 v228, v218
s_nop 0
v_pk_mul_f32 v[0:1], v[0:1], v[228:229] op_sel_hi:[1,0]
v_pk_mul_f32 v[2:3], v[2:3], v[228:229] op_sel_hi:[1,0]
v_cvt_pk_bf16_f32 v0, v0, v1
v_cvt_pk_bf16_f32 v1, v2, v3
ds_write_b64 v226, v[0:1] offset:0
v_pk_mul_f32 v[4:5], v[4:5], v[228:229] op_sel_hi:[1,0]
v_pk_mul_f32 v[6:7], v[6:7], v[228:229] op_sel_hi:[1,0]
v_cvt_pk_bf16_f32 v4, v4, v5
v_cvt_pk_bf16_f32 v5, v6, v7
ds_write_b64 v226, v[4:5] offset:32
v_pk_mul_f32 v[8:9], v[8:9], v[228:229] op_sel_hi:[1,0]
v_pk_mul_f32 v[10:11], v[10:11], v[228:229] op_sel_hi:[1,0]
v_cvt_pk_bf16_f32 v8, v8, v9
v_cvt_pk_bf16_f32 v9, v10, v11
ds_write_b64 v226, v[8:9] offset:64
v_pk_mul_f32 v[12:13], v[12:13], v[228:229] op_sel_hi:[1,0]
v_pk_mul_f32 v[14:15], v[14:15], v[228:229] op_sel_hi:[1,0]
v_cvt_pk_bf16_f32 v12, v12, v13
v_cvt_pk_bf16_f32 v13, v14, v15
ds_write_b64 v226, v[12:13] offset:96
v_pk_mul_f32 v[16:17], v[16:17], v[228:229] op_sel_hi:[1,0]
v_pk_mul_f32 v[18:19], v[18:19], v[228:229] op_sel_hi:[1,0]
v_cvt_pk_bf16_f32 v16, v16, v17
v_cvt_pk_bf16_f32 v17, v18, v19
ds_write_b64 v226, v[16:17] offset:128
v_pk_mul_f32 v[20:21], v[20:21], v[228:229] op_sel_hi:[1,0]
v_pk_mul_f32 v[22:23], v[22:23], v[228:229] op_sel_hi:[1,0]
v_cvt_pk_bf16_f32 v20, v20, v21
v_cvt_pk_bf16_f32 v21, v22, v23
ds_write_b64 v226, v[20:21] offset:160
v_pk_mul_f32 v[24:25], v[24:25], v[228:229] op_sel_hi:[1,0]
v_pk_mul_f32 v[26:27], v[26:27], v[228:229] op_sel_hi:[1,0]
v_cvt_pk_bf16_f32 v24, v24, v25
v_cvt_pk_bf16_f32 v25, v26, v27
ds_write_b64 v226, v[24:25] offset:192
v_pk_mul_f32 v[28:29], v[28:29], v[228:229] op_sel_hi:[1,0]
v_pk_mul_f32 v[30:31], v[30:31], v[228:229] op_sel_hi:[1,0]
v_cvt_pk_bf16_f32 v28, v28, v29
v_cvt_pk_bf16_f32 v29, v30, v31
ds_write_b64 v226, v[28:29] offset:224
ds_read_b128 v[240:243], v227 offset:0
ds_read_b128 v[244:247], v227 offset:1088
ds_read_b128 v[248:251], v227 offset:2176
ds_read_b128 v[252:255], v227 offset:3264
v_add_u32 v231, 8192, v229
s_waitcnt lgkmcnt(0)
buffer_store_dwordx4 v[240:243], v231, s[28:31], 0 offen offset:0 nt
buffer_store_dwordx4 v[244:247], v231, s[28:31], 0 offen offset:1024 nt
buffer_store_dwordx4 v[248:251], v231, s[28:31], 0 offen offset:2048 nt
buffer_store_dwordx4 v[252:255], v231, s[28:31], 0 offen offset:3072 nt
v_mov_b32 v230, v219
s_nop 1
v_permlane32_swap_b32 v219, v230
v_add_f32 v219, v219, v230
v_mov_b32 v230, v219
s_nop 1
v_permlane16_swap_b32 v219, v230
v_add_f32 v219, v219, v230
v_rcp_f32 v228, v219
s_nop 0
v_pk_mul_f32 v[32:33], v[32:33], v[228:229] op_sel_hi:[1,0]
v_pk_mul_f32 v[34:35], v[34:35], v[228:229] op_sel_hi:[1,0]
v_cvt_pk_bf16_f32 v32, v32, v33
v_cvt_pk_bf16_f32 v33, v34, v35
ds_write_b64 v226, v[32:33] offset:0
v_pk_mul_f32 v[36:37], v[36:37], v[228:229] op_sel_hi:[1,0]
v_pk_mul_f32 v[38:39], v[38:39], v[228:229] op_sel_hi:[1,0]
v_cvt_pk_bf16_f32 v36, v36, v37
v_cvt_pk_bf16_f32 v37, v38, v39
ds_write_b64 v226, v[36:37] offset:32
v_pk_mul_f32 v[40:41], v[40:41], v[228:229] op_sel_hi:[1,0]
v_pk_mul_f32 v[42:43], v[42:43], v[228:229] op_sel_hi:[1,0]
v_cvt_pk_bf16_f32 v40, v40, v41
v_cvt_pk_bf16_f32 v41, v42, v43
ds_write_b64 v226, v[40:41] offset:64
v_pk_mul_f32 v[44:45], v[44:45], v[228:229] op_sel_hi:[1,0]
v_pk_mul_f32 v[46:47], v[46:47], v[228:229] op_sel_hi:[1,0]
v_cvt_pk_bf16_f32 v44, v44, v45
v_cvt_pk_bf16_f32 v45, v46, v47
ds_write_b64 v226, v[44:45] offset:96
v_pk_mul_f32 v[48:49], v[48:49], v[228:229] op_sel_hi:[1,0]
v_pk_mul_f32 v[50:51], v[50:51], v[228:229] op_sel_hi:[1,0]
v_cvt_pk_bf16_f32 v48, v48, v49
v_cvt_pk_bf16_f32 v49, v50, v51
ds_write_b64 v226, v[48:49] offset:128
v_pk_mul_f32 v[52:53], v[52:53], v[228:229] op_sel_hi:[1,0]
v_pk_mul_f32 v[54:55], v[54:55], v[228:229] op_sel_hi:[1,0]
v_cvt_pk_bf16_f32 v52, v52, v53
v_cvt_pk_bf16_f32 v53, v54, v55
ds_write_b64 v226, v[52:53] offset:160
v_pk_mul_f32 v[56:57], v[56:57], v[228:229] op_sel_hi:[1,0]
v_pk_mul_f32 v[58:59], v[58:59], v[228:229] op_sel_hi:[1,0]
v_cvt_pk_bf16_f32 v56, v56, v57
v_cvt_pk_bf16_f32 v57, v58, v59
ds_write_b64 v226, v[56:57] offset:192
v_pk_mul_f32 v[60:61], v[60:61], v[228:229] op_sel_hi:[1,0]
v_pk_mul_f32 v[62:63], v[62:63], v[228:229] op_sel_hi:[1,0]
v_cvt_pk_bf16_f32 v60, v60, v61
v_cvt_pk_bf16_f32 v61, v62, v63
ds_write_b64 v226, v[60:61] offset:224
ds_read_b128 v[240:243], v227 offset:0
ds_read_b128 v[244:247], v227 offset:1088
ds_read_b128 v[248:251], v227 offset:2176
ds_read_b128 v[252:255], v227 offset:3264
v_add_u32 v231, 12288, v229
s_waitcnt lgkmcnt(0)
buffer_store_dwordx4 v[240:243], v231, s[28:31], 0 offen offset:0 nt
buffer_store_dwordx4 v[244:247], v231, s[28:31], 0 offen offset:1024 nt
buffer_store_dwordx4 v[248:251], v231, s[28:31], 0 offen offset:2048 nt
buffer_store_dwordx4 v[252:255], v231, s[28:31], 0 offen offset:3072 nt
v_mov_b32 v230, v220
s_nop 1
v_permlane32_swap_b32 v220, v230
v_add_f32 v220, v220, v230
v_mov_b32 v230, v220
s_nop 1
v_permlane16_swap_b32 v220, v230
v_add_f32 v220, v220, v230
v_rcp_f32 v228, v220
s_nop 0
v_pk_mul_f32 v[64:65], v[64:65], v[228:229] op_sel_hi:[1,0]
v_pk_mul_f32 v[66:67], v[66:67], v[228:229] op_sel_hi:[1,0]
v_cvt_pk_bf16_f32 v64, v64, v65
v_cvt_pk_bf16_f32 v65, v66, v67
ds_write_b64 v226, v[64:65] offset:0
v_pk_mul_f32 v[68:69], v[68:69], v[228:229] op_sel_hi:[1,0]
v_pk_mul_f32 v[70:71], v[70:71], v[228:229] op_sel_hi:[1,0]
v_cvt_pk_bf16_f32 v68, v68, v69
v_cvt_pk_bf16_f32 v69, v70, v71
ds_write_b64 v226, v[68:69] offset:32
v_pk_mul_f32 v[72:73], v[72:73], v[228:229] op_sel_hi:[1,0]
v_pk_mul_f32 v[74:75], v[74:75], v[228:229] op_sel_hi:[1,0]
v_cvt_pk_bf16_f32 v72, v72, v73
v_cvt_pk_bf16_f32 v73, v74, v75
ds_write_b64 v226, v[72:73] offset:64
v_pk_mul_f32 v[76:77], v[76:77], v[228:229] op_sel_hi:[1,0]
v_pk_mul_f32 v[78:79], v[78:79], v[228:229] op_sel_hi:[1,0]
v_cvt_pk_bf16_f32 v76, v76, v77
v_cvt_pk_bf16_f32 v77, v78, v79
ds_write_b64 v226, v[76:77] offset:96
v_pk_mul_f32 v[80:81], v[80:81], v[228:229] op_sel_hi:[1,0]
v_pk_mul_f32 v[82:83], v[82:83], v[228:229] op_sel_hi:[1,0]
v_cvt_pk_bf16_f32 v80, v80, v81
v_cvt_pk_bf16_f32 v81, v82, v83
ds_write_b64 v226, v[80:81] offset:128
v_pk_mul_f32 v[84:85], v[84:85], v[228:229] op_sel_hi:[1,0]
v_pk_mul_f32 v[86:87], v[86:87], v[228:229] op_sel_hi:[1,0]
v_cvt_pk_bf16_f32 v84, v84, v85
v_cvt_pk_bf16_f32 v85, v86, v87
ds_write_b64 v226, v[84:85] offset:160
v_pk_mul_f32 v[88:89], v[88:89], v[228:229] op_sel_hi:[1,0]
v_pk_mul_f32 v[90:91], v[90:91], v[228:229] op_sel_hi:[1,0]
v_cvt_pk_bf16_f32 v88, v88, v89
v_cvt_pk_bf16_f32 v89, v90, v91
ds_write_b64 v226, v[88:89] offset:192
v_pk_mul_f32 v[92:93], v[92:93], v[228:229] op_sel_hi:[1,0]
v_pk_mul_f32 v[94:95], v[94:95], v[228:229] op_sel_hi:[1,0]
v_cvt_pk_bf16_f32 v92, v92, v93
v_cvt_pk_bf16_f32 v93, v94, v95
ds_write_b64 v226, v[92:93] offset:224
ds_read_b128 v[240:243], v227 offset:0
ds_read_b128 v[244:247], v227 offset:1088
ds_read_b128 v[248:251], v227 offset:2176
ds_read_b128 v[252:255], v227 offset:3264
v_add_u32 v231, 16384, v229
s_waitcnt lgkmcnt(0)
buffer_store_dwordx4 v[240:243], v231, s[28:31], 0 offen offset:0 nt
buffer_store_dwordx4 v[244:247], v231, s[28:31], 0 offen offset:1024 nt
buffer_store_dwordx4 v[248:251], v231, s[28:31], 0 offen offset:2048 nt
buffer_store_dwordx4 v[252:255], v231, s[28:31], 0 offen offset:3072 nt
v_mov_b32 v230, v221
s_nop 1
v_permlane32_swap_b32 v221, v230
v_add_f32 v221, v221, v230
v_mov_b32 v230, v221
s_nop 1
v_permlane16_swap_b32 v221, v230
v_add_f32 v221, v221, v230
v_rcp_f32 v228, v221
s_nop 0
v_pk_mul_f32 v[96:97], v[96:97], v[228:229] op_sel_hi:[1,0]
v_pk_mul_f32 v[98:99], v[98:99], v[228:229] op_sel_hi:[1,0]
v_cvt_pk_bf16_f32 v96, v96, v97
v_cvt_pk_bf16_f32 v97, v98, v99
ds_write_b64 v226, v[96:97] offset:0
v_pk_mul_f32 v[100:101], v[100:101], v[228:229] op_sel_hi:[1,0]
v_pk_mul_f32 v[102:103], v[102:103], v[228:229] op_sel_hi:[1,0]
v_cvt_pk_bf16_f32 v100, v100, v101
v_cvt_pk_bf16_f32 v101, v102, v103
ds_write_b64 v226, v[100:101] offset:32
v_pk_mul_f32 v[104:105], v[104:105], v[228:229] op_sel_hi:[1,0]
v_pk_mul_f32 v[106:107], v[106:107], v[228:229] op_sel_hi:[1,0]
v_cvt_pk_bf16_f32 v104, v104, v105
v_cvt_pk_bf16_f32 v105, v106, v107
ds_write_b64 v226, v[104:105] offset:64
v_pk_mul_f32 v[108:109], v[108:109], v[228:229] op_sel_hi:[1,0]
v_pk_mul_f32 v[110:111], v[110:111], v[228:229] op_sel_hi:[1,0]
v_cvt_pk_bf16_f32 v108, v108, v109
v_cvt_pk_bf16_f32 v109, v110, v111
ds_write_b64 v226, v[108:109] offset:96
v_pk_mul_f32 v[112:113], v[112:113], v[228:229] op_sel_hi:[1,0]
v_pk_mul_f32 v[114:115], v[114:115], v[228:229] op_sel_hi:[1,0]
v_cvt_pk_bf16_f32 v112, v112, v113
v_cvt_pk_bf16_f32 v113, v114, v115
ds_write_b64 v226, v[112:113] offset:128
v_pk_mul_f32 v[116:117], v[116:117], v[228:229] op_sel_hi:[1,0]
v_pk_mul_f32 v[118:119], v[118:119], v[228:229] op_sel_hi:[1,0]
v_cvt_pk_bf16_f32 v116, v116, v117
v_cvt_pk_bf16_f32 v117, v118, v119
ds_write_b64 v226, v[116:117] offset:160
v_pk_mul_f32 v[120:121], v[120:121], v[228:229] op_sel_hi:[1,0]
v_pk_mul_f32 v[122:123], v[122:123], v[228:229] op_sel_hi:[1,0]
v_cvt_pk_bf16_f32 v120, v120, v121
v_cvt_pk_bf16_f32 v121, v122, v123
ds_write_b64 v226, v[120:121] offset:192
v_pk_mul_f32 v[124:125], v[124:125], v[228:229] op_sel_hi:[1,0]
v_pk_mul_f32 v[126:127], v[126:127], v[228:229] op_sel_hi:[1,0]
v_cvt_pk_bf16_f32 v124, v124, v125
v_cvt_pk_bf16_f32 v125, v126, v127
ds_write_b64 v226, v[124:125] offset:224
ds_read_b128 v[240:243], v227 offset:0
ds_read_b128 v[244:247], v227 offset:1088
ds_read_b128 v[248:251], v227 offset:2176
ds_read_b128 v[252:255], v227 offset:3264
v_add_u32 v231, 20480, v229
s_waitcnt lgkmcnt(0)
buffer_store_dwordx4 v[240:243], v231, s[28:31], 0 offen offset:0 nt
buffer_store_dwordx4 v[244:247], v231, s[28:31], 0 offen offset:1024 nt
buffer_store_dwordx4 v[248:251], v231, s[28:31], 0 offen offset:2048 nt
buffer_store_dwordx4 v[252:255], v231, s[28:31], 0 offen offset:3072 nt
v_mov_b32 v230, v222
s_nop 1
v_permlane32_swap_b32 v222, v230
v_add_f32 v222, v222, v230
v_mov_b32 v230, v222
s_nop 1
v_permlane16_swap_b32 v222, v230
v_add_f32 v222, v222, v230
v_rcp_f32 v228, v222
s_nop 0
v_pk_mul_f32 v[128:129], v[128:129], v[228:229] op_sel_hi:[1,0]
v_pk_mul_f32 v[130:131], v[130:131], v[228:229] op_sel_hi:[1,0]
v_cvt_pk_bf16_f32 v128, v128, v129
v_cvt_pk_bf16_f32 v129, v130, v131
ds_write_b64 v226, v[128:129] offset:0
v_pk_mul_f32 v[132:133], v[132:133], v[228:229] op_sel_hi:[1,0]
v_pk_mul_f32 v[134:135], v[134:135], v[228:229] op_sel_hi:[1,0]
v_cvt_pk_bf16_f32 v132, v132, v133
v_cvt_pk_bf16_f32 v133, v134, v135
ds_write_b64 v226, v[132:133] offset:32
v_pk_mul_f32 v[136:137], v[136:137], v[228:229] op_sel_hi:[1,0]
v_pk_mul_f32 v[138:139], v[138:139], v[228:229] op_sel_hi:[1,0]
v_cvt_pk_bf16_f32 v136, v136, v137
v_cvt_pk_bf16_f32 v137, v138, v139
ds_write_b64 v226, v[136:137] offset:64
v_pk_mul_f32 v[140:141], v[140:141], v[228:229] op_sel_hi:[1,0]
v_pk_mul_f32 v[142:143], v[142:143], v[228:229] op_sel_hi:[1,0]
v_cvt_pk_bf16_f32 v140, v140, v141
v_cvt_pk_bf16_f32 v141, v142, v143
ds_write_b64 v226, v[140:141] offset:96
v_pk_mul_f32 v[144:145], v[144:145], v[228:229] op_sel_hi:[1,0]
v_pk_mul_f32 v[146:147], v[146:147], v[228:229] op_sel_hi:[1,0]
v_cvt_pk_bf16_f32 v144, v144, v145
v_cvt_pk_bf16_f32 v145, v146, v147
ds_write_b64 v226, v[144:145] offset:128
v_pk_mul_f32 v[148:149], v[148:149], v[228:229] op_sel_hi:[1,0]
v_pk_mul_f32 v[150:151], v[150:151], v[228:229] op_sel_hi:[1,0]
v_cvt_pk_bf16_f32 v148, v148, v149
v_cvt_pk_bf16_f32 v149, v150, v151
ds_write_b64 v226, v[148:149] offset:160
v_pk_mul_f32 v[152:153], v[152:153], v[228:229] op_sel_hi:[1,0]
v_pk_mul_f32 v[154:155], v[154:155], v[228:229] op_sel_hi:[1,0]
v_cvt_pk_bf16_f32 v152, v152, v153
v_cvt_pk_bf16_f32 v153, v154, v155
ds_write_b64 v226, v[152:153] offset:192
v_pk_mul_f32 v[156:157], v[156:157], v[228:229] op_sel_hi:[1,0]
v_pk_mul_f32 v[158:159], v[158:159], v[228:229] op_sel_hi:[1,0]
v_cvt_pk_bf16_f32 v156, v156, v157
v_cvt_pk_bf16_f32 v157, v158, v159
ds_write_b64 v226, v[156:157] offset:224
ds_read_b128 v[240:243], v227 offset:0
ds_read_b128 v[244:247], v227 offset:1088
ds_read_b128 v[248:251], v227 offset:2176
ds_read_b128 v[252:255], v227 offset:3264
v_add_u32 v231, 24576, v229
s_waitcnt lgkmcnt(0)
buffer_store_dwordx4 v[240:243], v231, s[28:31], 0 offen offset:0 nt
buffer_store_dwordx4 v[244:247], v231, s[28:31], 0 offen offset:1024 nt
buffer_store_dwordx4 v[248:251], v231, s[28:31], 0 offen offset:2048 nt
buffer_store_dwordx4 v[252:255], v231, s[28:31], 0 offen offset:3072 nt
v_mov_b32 v230, v223
s_nop 1
v_permlane32_swap_b32 v223, v230
v_add_f32 v223, v223, v230
v_mov_b32 v230, v223
s_nop 1
v_permlane16_swap_b32 v223, v230
v_add_f32 v223, v223, v230
v_rcp_f32 v228, v223
s_nop 0
v_pk_mul_f32 v[160:161], v[160:161], v[228:229] op_sel_hi:[1,0]
v_pk_mul_f32 v[162:163], v[162:163], v[228:229] op_sel_hi:[1,0]
v_cvt_pk_bf16_f32 v160, v160, v161
v_cvt_pk_bf16_f32 v161, v162, v163
ds_write_b64 v226, v[160:161] offset:0
v_pk_mul_f32 v[164:165], v[164:165], v[228:229] op_sel_hi:[1,0]
v_pk_mul_f32 v[166:167], v[166:167], v[228:229] op_sel_hi:[1,0]
v_cvt_pk_bf16_f32 v164, v164, v165
v_cvt_pk_bf16_f32 v165, v166, v167
ds_write_b64 v226, v[164:165] offset:32
v_pk_mul_f32 v[168:169], v[168:169], v[228:229] op_sel_hi:[1,0]
v_pk_mul_f32 v[170:171], v[170:171], v[228:229] op_sel_hi:[1,0]
v_cvt_pk_bf16_f32 v168, v168, v169
v_cvt_pk_bf16_f32 v169, v170, v171
ds_write_b64 v226, v[168:169] offset:64
v_pk_mul_f32 v[172:173], v[172:173], v[228:229] op_sel_hi:[1,0]
v_pk_mul_f32 v[174:175], v[174:175], v[228:229] op_sel_hi:[1,0]
v_cvt_pk_bf16_f32 v172, v172, v173
v_cvt_pk_bf16_f32 v173, v174, v175
ds_write_b64 v226, v[172:173] offset:96
v_pk_mul_f32 v[176:177], v[176:177], v[228:229] op_sel_hi:[1,0]
v_pk_mul_f32 v[178:179], v[178:179], v[228:229] op_sel_hi:[1,0]
v_cvt_pk_bf16_f32 v176, v176, v177
v_cvt_pk_bf16_f32 v177, v178, v179
ds_write_b64 v226, v[176:177] offset:128
v_pk_mul_f32 v[180:181], v[180:181], v[228:229] op_sel_hi:[1,0]
v_pk_mul_f32 v[182:183], v[182:183], v[228:229] op_sel_hi:[1,0]
v_cvt_pk_bf16_f32 v180, v180, v181
v_cvt_pk_bf16_f32 v181, v182, v183
ds_write_b64 v226, v[180:181] offset:160
v_pk_mul_f32 v[184:185], v[184:185], v[228:229] op_sel_hi:[1,0]
v_pk_mul_f32 v[186:187], v[186:187], v[228:229] op_sel_hi:[1,0]
v_cvt_pk_bf16_f32 v184, v184, v185
v_cvt_pk_bf16_f32 v185, v186, v187
ds_write_b64 v226, v[184:185] offset:192
v_pk_mul_f32 v[188:189], v[188:189], v[228:229] op_sel_hi:[1,0]
v_pk_mul_f32 v[190:191], v[190:191], v[228:229] op_sel_hi:[1,0]
v_cvt_pk_bf16_f32 v188, v188, v189
v_cvt_pk_bf16_f32 v189, v190, v191
ds_write_b64 v226, v[188:189] offset:224
ds_read_b128 v[240:243], v227 offset:0
ds_read_b128 v[244:247], v227 offset:1088
ds_read_b128 v[248:251], v227 offset:2176
ds_read_b128 v[252:255], v227 offset:3264
v_add_u32 v231, 28672, v229
s_waitcnt lgkmcnt(0)
buffer_store_dwordx4 v[240:243], v231, s[28:31], 0 offen offset:0 nt
buffer_store_dwordx4 v[244:247], v231, s[28:31], 0 offen offset:1024 nt
buffer_store_dwordx4 v[248:251], v231, s[28:31], 0 offen offset:2048 nt
buffer_store_dwordx4 v[252:255], v231, s[28:31], 0 offen offset:3072 nt
L_done:
L_end:
s_endpgm
.section .rodata,"a"
.p2align 6
.amdhsa_kernel standalone__gqa_softmax__near_ridge_kernel
  .amdhsa_next_free_vgpr 512
  .amdhsa_next_free_sgpr 102
  .amdhsa_accum_offset 256
  .amdhsa_group_segment_fixed_size 0
  .amdhsa_kernarg_size 48
  .amdhsa_float_denorm_mode_32 3
  .amdhsa_user_sgpr_count 2
  .amdhsa_user_sgpr_kernarg_segment_ptr 1
  .amdhsa_system_sgpr_workgroup_id_x 1
.end_amdhsa_kernel
```
